```python
import torch

def _softmax(x, axis=-1):
    return torch.softmax(x, dim=axis)
def _gelu(x):
    return torch.nn.functional.gelu(x, approximate="tanh")
def _silu(x):
    return torch.nn.functional.silu(x)
def _sigmoid(x):
    return torch.sigmoid(x)
def _layernorm(x, axis=-1, eps=1e-5):
    m = x.mean(dim=axis, keepdim=True)
    v = x.var(dim=axis, keepdim=True, unbiased=False)
    return (x - m) / torch.sqrt(v + eps)
def _scatter_add(tgt, idx, src, axis=0):
    return tgt.clone().index_add_(axis, idx, src)
def _segment_sum(src, seg, n):
    out = torch.zeros((n,) + src.shape[1:], dtype=src.dtype)
    return out.index_add_(0, seg, src)
def _pad(x, pw):
    flat = tuple(v for pair in reversed(pw) for v in pair)
    return torch.nn.functional.pad(x, flat)

kernel_name = 'gated_mix__spectral_gfnet__ssm_conv_s4__prompt'

def setup_inputs():

    _w = (lambda a: (lambda t: t.to(torch.bfloat16) if t.is_floating_point() else t)(torch.as_tensor(a)))
    def _A_setup():
        B, S, D = 1, 2048, 448
        Df = D // 2 + 1
        return {
            "x": _w((lambda *s: torch.randn(*s, dtype=torch.bfloat16) * 0.05)(B, S, D)),
            "w_r": _w((lambda *s: torch.randn(*s, dtype=torch.bfloat16) * 0.8)(S, Df) * 0.02),
            "w_i": _w((lambda *s: torch.randn(*s, dtype=torch.bfloat16) * 0.8)(S, Df) * 0.02),
        }
    _A_in = _A_setup()

    def _B_setup():
        B, L, D, N = 1, 2048, 448, 256
        A_re = -(lambda _x: torch.exp(torch.as_tensor(_x)))((lambda *s: torch.randn(*s, dtype=torch.bfloat16) * 3.2)(D, N))
        A_im = torch.pi * (lambda *s: torch.randn(*s, dtype=torch.bfloat16) * 0.05)(D, N)
        B_re = (lambda *s: torch.randn(*s, dtype=torch.bfloat16) * 0.05)(D, N)
        B_im = (lambda *s: torch.randn(*s, dtype=torch.bfloat16) * 0.05)(D, N)
        C_re = (lambda *s: torch.randn(*s, dtype=torch.bfloat16) * 0.05)(D, N)
        C_im = (lambda *s: torch.randn(*s, dtype=torch.bfloat16) * 0.1)(D, N)
        log_dt = (lambda *s: torch.randn(*s, dtype=torch.bfloat16) * 0.05)(D) * 0.5 - 4.0
        Dskip = (lambda *s: torch.randn(*s, dtype=torch.bfloat16) * 0.05)(D)
        return {
            "u": _w((lambda *s: torch.randn(*s, dtype=torch.bfloat16) * 0.05)(B, L, D)),
            "A_re": _w(A_re),
            "A_im": _w(A_im),
            "B_re": _w(B_re),
            "B_im": _w(B_im),
            "C_re": _w(C_re),
            "C_im": _w(C_im),
            "log_dt": _w(log_dt),
            "Dskip": _w(Dskip),
        }
    _B_in = _B_setup()

    return {
        "A_x": _A_in["x"],
        "A_w_r": _A_in["w_r"],
        "A_w_i": _A_in["w_i"],
        "B_u": _B_in["u"],
        "B_A_re": _B_in["A_re"],
        "B_A_im": _B_in["A_im"],
        "B_B_re": _B_in["B_re"],
        "B_B_im": _B_in["B_im"],
        "B_C_re": _B_in["C_re"],
        "B_C_im": _B_in["C_im"],
        "B_log_dt": _B_in["log_dt"],
        "B_Dskip": _B_in["Dskip"],
        "gate_w": _w((lambda *s: torch.randn(*s, dtype=torch.bfloat16) * 0.05)(448) * 16.0),
    }

def reference(A_x, A_w_r, A_w_i, B_u, B_A_re, B_A_im, B_B_re, B_B_im, B_C_re, B_C_im, B_log_dt, B_Dskip, gate_w):
    def _A_ref(x, w_r, w_i):
        B, S, D = x.shape
        X = (lambda x, axes=(-2,-1): torch.fft.rfft2(x.float(), dim=axes))(x, axes=(-2, -1))
        W = w_r + 1j * w_i
        X = X * W
        y = (lambda x, s, axes=(-2,-1): torch.fft.irfft2(x, s=s, dim=axes).to(torch.bfloat16))(X, (S, D), axes=(-2, -1))
        return y

    def _B_ref(u, A_re, A_im, B_re, B_im, C_re, C_im, log_dt, Dskip):
        Bsz, L, D = u.shape
        dt = torch.exp(log_dt)[:, None]
        A = A_re + 1j * A_im
        Bc = B_re + 1j * B_im
        Cc = C_re + 1j * C_im
        logdA = dt * A
        dB = dt * Bc
        l = (lambda x, dt: x.to(dt))(torch.arange(L), A_re.dtype)
        P = torch.exp(logdA[:, :, None] * l[None, None, :])
        K = torch.einsum("dn,dnl,dn->dl", Cc, P, dB).real
        L2 = 2 * L
        Kp = _pad(K, ((0, 0), (0, L)))
        up = (lambda x, *d: x.permute(*d))(u, 0, 2, 1)
        up = _pad(up, ((0, 0), (0, 0), (0, L)))
        Kf = (lambda x, axes=(-2,-1): torch.fft.rfft2(x.float(), dim=axes))(Kp[:, None, :], axes=(-2, -1))
        Uf = (lambda x, axes=(-2,-1): torch.fft.rfft2(x.float(), dim=axes))(up[:, :, None, :], axes=(-2, -1))
        Yf = Uf * Kf[None, :, :, :]
        y = (lambda x, s, axes=(-2,-1): torch.fft.irfft2(x, s=s, dim=axes).to(torch.bfloat16))(Yf, (1, L2), axes=(-2, -1))[:, :, 0, :L]
        y = (lambda x, *d: x.permute(*d))(y, 0, 2, 1) + u * Dskip[None, None, :]
        return y

    x = A_x
    g = _sigmoid((x * gate_w).sum(-1, keepdims=True))
    a = _A_ref(x, A_w_r, A_w_i)
    b = _B_ref(x, B_A_re, B_A_im, B_B_re, B_B_im, B_C_re, B_C_im, B_log_dt, B_Dskip)
    return g * a + (1 - g) * b
```

```asm
; @launch grid=(704,1,1) block=(256,1,1) lds=53760
.amdgcn_target "amdgcn-amd-amdhsa--gfx950"
.text
.globl gated_mix__spectral_gfnet__ssm_conv_s4__prompt_kernel
.p2align 8
.type gated_mix__spectral_gfnet__ssm_conv_s4__prompt_kernel,@function
gated_mix__spectral_gfnet__ssm_conv_s4__prompt_kernel:
    s_load_dwordx2 s[4:5], s[0:1], 0
    s_load_dwordx16 s[16:31], s[0:1], 0
    s_load_dwordx16 s[32:47], s[0:1], 64
    s_cmp_ge_u32 s2, 32
    s_cbranch_scc1 L_E1
    s_getpc_b64 s[50:51]
L_PC:
    v_lshlrev_b32 v4, 7, v0
    v_min_u32 v4, L_CODE_END-L_PC-4, v4
    v_add_co_u32 v4, vcc, s50, v4
    v_mov_b32 v5, s51
    s_nop 0
    v_addc_co_u32 v5, vcc, 0, v5, vcc
    global_load_dword v151, v[4:5], off
L_E1:
    s_load_dwordx2 s[8:9], s[0:1], 120
    v_lshrrev_b32 v2, 6, v0
    v_and_b32 v1, 63, v0
    s_setprio 3
    v_readfirstlane_b32 s48, v2
    s_mov_b32 s6, 1835008
    s_mov_b32 s7, 0x20000
    v_lshlrev_b32 v3, 4, v1
    s_sub_u32 s49, s2, 256
    s_cbranch_scc1 L_A0
    s_cmp_ge_u32 s49, 448
    s_cbranch_scc1 L_EXIT
    s_lshl_b32 s50, s49, 9
    v_lshl_add_u32 v143, v0, 1, s50
    s_lshl_b32 s50, s49, 1
    v_mov_b32 v144, s50
    s_waitcnt lgkmcnt(0)
    global_load_short_d16_hi v8, v144, s[36:37]
    global_load_short_d16_hi v2, v143, s[24:25] nt
    global_load_short_d16_hi v36, v143, s[26:27] nt
    s_branch L_B
L_A0:
    s_and_b32 s49, s2, 7
    s_lshl_b32 s49, s49, 3
    s_bfe_u32 s55, s2, 0x30003
    s_or_b32 s49, s49, s55
    s_lshl_b32 s55, s48, 9
    s_add_u32 s55, s55, s49
    s_mul_i32 s55, s55, 896
    s_mul_i32 m0, s48, 7296
    s_lshr_b32 s50, s2, 6
    s_xor_b32 s50, s50, 3
    s_lshl_b32 s51, s50, 2
    s_add_u32 s51, s51, s48
    s_lshr_b32 s58, s51, 1
    s_mul_i32 s56, s58, 30
    s_and_b32 s57, s51, 1
    s_add_u32 s56, s56, s57
    v_and_b32 v7, 15, v1
    v_lshrrev_b32 v14, 5, v1
    v_lshl_add_u32 v4, v7, 1, s56
    v_cvt_f32_u32 v4, v4
    v_mul_f32 v4, 0x3b124925, v4
    v_cvt_f32_u32 v5, v14
    v_and_b32 v6, 16, v1
    v_cvt_f32_u32 v6, v6
    v_mul_f32 v6, 0x3c800000, v6
    v_mul_f32 v9, 0x41000000, v4
    v_fma_f32 v8, v9, v5, v6
    v_add_f32 v9, v9, v9
    v_cos_f32 v12, v9
    v_fmamk_f32 v9, v4, 0x00000000, v8
    v_fmamk_f32 v10, v4, 0x41800000, v8
    v_cos_f32 v104, v9
    v_cos_f32 v112, v10
    v_fmamk_f32 v9, v4, 0x3f800000, v8
    v_fmamk_f32 v10, v4, 0x41880000, v8
    v_cos_f32 v105, v9
    v_cos_f32 v113, v10
    v_fmamk_f32 v9, v4, 0x40000000, v8
    v_fmamk_f32 v10, v4, 0x41900000, v8
    v_cos_f32 v106, v9
    v_cos_f32 v114, v10
    v_fmamk_f32 v9, v4, 0x40400000, v8
    v_fmamk_f32 v10, v4, 0x41980000, v8
    v_cos_f32 v107, v9
    v_cos_f32 v115, v10
    s_mov_b32 s59, s55
    s_waitcnt lgkmcnt(0)
    s_mov_b32 exec_hi, 0x00ffffff
    buffer_load_dwordx4 v3, s[4:7], s59 offen nt lds
    s_mov_b32 exec_hi, -1
    s_add_u32 m0, m0, 912
    s_add_u32 s59, s59, 57344
    s_mov_b32 exec_hi, -1
    s_mov_b32 s10, 4718592
    s_mov_b32 s11, 0x20000
    v_fmamk_f32 v9, v4, 0x40800000, v8
    v_fmamk_f32 v10, v4, 0x41a00000, v8
    v_cos_f32 v108, v9
    v_cos_f32 v116, v10
    v_fmamk_f32 v9, v4, 0x40a00000, v8
    s_mov_b32 exec_hi, 0x00ffffff
    buffer_load_dwordx4 v3, s[4:7], s59 offen nt lds
    s_mov_b32 exec_hi, -1
    s_add_u32 m0, m0, 912
    s_add_u32 s59, s59, 57344
    v_fmamk_f32 v10, v4, 0x41a80000, v8
    v_cos_f32 v109, v9
    v_cos_f32 v117, v10
    v_fmamk_f32 v9, v4, 0x40c00000, v8
    v_fmamk_f32 v10, v4, 0x41b00000, v8
    v_cos_f32 v110, v9
    v_cos_f32 v118, v10
    s_mov_b32 exec_hi, 0x00ffffff
    buffer_load_dwordx4 v3, s[4:7], s59 offen nt lds
    s_mov_b32 exec_hi, -1
    s_add_u32 m0, m0, 912
    s_add_u32 s59, s59, 57344
    v_fmamk_f32 v9, v4, 0x40e00000, v8
    v_fmamk_f32 v10, v4, 0x41b80000, v8
    v_cos_f32 v111, v9
    v_cos_f32 v119, v10
    v_add_f32 v12, v12, v12
    v_cvt_pk_bf16_f32 v16, v104, v105
    v_cvt_pk_bf16_f32 v17, v106, v107
    v_cvt_pk_bf16_f32 v18, v108, v109
    s_mov_b32 exec_hi, 0x00ffffff
    buffer_load_dwordx4 v3, s[4:7], s59 offen nt lds
    s_mov_b32 exec_hi, -1
    s_add_u32 m0, m0, 912
    s_add_u32 s59, s59, 57344
    v_cvt_pk_bf16_f32 v19, v110, v111
    v_pk_fma_f32 v[104:105], v[12:13], v[112:113], v[104:105] op_sel_hi:[0,1,1] neg_lo:[0,0,1] neg_hi:[0,0,1]
    v_pk_fma_f32 v[106:107], v[12:13], v[114:115], v[106:107] op_sel_hi:[0,1,1] neg_lo:[0,0,1] neg_hi:[0,0,1]
    v_pk_fma_f32 v[108:109], v[12:13], v[116:117], v[108:109] op_sel_hi:[0,1,1] neg_lo:[0,0,1] neg_hi:[0,0,1]
    v_pk_fma_f32 v[110:111], v[12:13], v[118:119], v[110:111] op_sel_hi:[0,1,1] neg_lo:[0,0,1] neg_hi:[0,0,1]
    v_cvt_pk_bf16_f32 v20, v112, v113
    v_cvt_pk_bf16_f32 v21, v114, v115
    v_cvt_pk_bf16_f32 v22, v116, v117
    v_cvt_pk_bf16_f32 v23, v118, v119
    v_pk_fma_f32 v[112:113], v[12:13], v[104:105], v[112:113] op_sel_hi:[0,1,1] neg_lo:[0,0,1] neg_hi:[0,0,1]
    s_mov_b32 exec_hi, 0x00ffffff
    buffer_load_dwordx4 v3, s[4:7], s59 offen nt lds
    s_mov_b32 exec_hi, -1
    s_add_u32 m0, m0, 912
    s_add_u32 s59, s59, 57344
    v_pk_fma_f32 v[114:115], v[12:13], v[106:107], v[114:115] op_sel_hi:[0,1,1] neg_lo:[0,0,1] neg_hi:[0,0,1]
    v_pk_fma_f32 v[116:117], v[12:13], v[108:109], v[116:117] op_sel_hi:[0,1,1] neg_lo:[0,0,1] neg_hi:[0,0,1]
    v_pk_fma_f32 v[118:119], v[12:13], v[110:111], v[118:119] op_sel_hi:[0,1,1] neg_lo:[0,0,1] neg_hi:[0,0,1]
    v_cvt_pk_bf16_f32 v24, v104, v105
    v_cvt_pk_bf16_f32 v25, v106, v107
    v_cvt_pk_bf16_f32 v26, v108, v109
    v_cvt_pk_bf16_f32 v27, v110, v111
    v_pk_fma_f32 v[104:105], v[12:13], v[112:113], v[104:105] op_sel_hi:[0,1,1] neg_lo:[0,0,1] neg_hi:[0,0,1]
    v_pk_fma_f32 v[106:107], v[12:13], v[114:115], v[106:107] op_sel_hi:[0,1,1] neg_lo:[0,0,1] neg_hi:[0,0,1]
    v_pk_fma_f32 v[108:109], v[12:13], v[116:117], v[108:109] op_sel_hi:[0,1,1] neg_lo:[0,0,1] neg_hi:[0,0,1]
    s_mov_b32 exec_hi, 0x00ffffff
    buffer_load_dwordx4 v3, s[4:7], s59 offen nt lds
    s_mov_b32 exec_hi, -1
    s_add_u32 m0, m0, 912
    s_add_u32 s59, s59, 57344
    v_pk_fma_f32 v[110:111], v[12:13], v[118:119], v[110:111] op_sel_hi:[0,1,1] neg_lo:[0,0,1] neg_hi:[0,0,1]
    v_cvt_pk_bf16_f32 v28, v112, v113
    v_cvt_pk_bf16_f32 v29, v114, v115
    v_cvt_pk_bf16_f32 v30, v116, v117
    v_cvt_pk_bf16_f32 v31, v118, v119
    v_pk_fma_f32 v[112:113], v[12:13], v[104:105], v[112:113] op_sel_hi:[0,1,1] neg_lo:[0,0,1] neg_hi:[0,0,1]
    v_pk_fma_f32 v[114:115], v[12:13], v[106:107], v[114:115] op_sel_hi:[0,1,1] neg_lo:[0,0,1] neg_hi:[0,0,1]
    v_pk_fma_f32 v[116:117], v[12:13], v[108:109], v[116:117] op_sel_hi:[0,1,1] neg_lo:[0,0,1] neg_hi:[0,0,1]
    v_pk_fma_f32 v[118:119], v[12:13], v[110:111], v[118:119] op_sel_hi:[0,1,1] neg_lo:[0,0,1] neg_hi:[0,0,1]
    v_cvt_pk_bf16_f32 v32, v104, v105
    s_mov_b32 exec_hi, 0x00ffffff
    buffer_load_dwordx4 v3, s[4:7], s59 offen nt lds
    s_mov_b32 exec_hi, -1
    s_add_u32 m0, m0, 912
    s_add_u32 s59, s59, 57344
    v_cvt_pk_bf16_f32 v33, v106, v107
    v_cvt_pk_bf16_f32 v34, v108, v109
    v_cvt_pk_bf16_f32 v35, v110, v111
    v_pk_fma_f32 v[104:105], v[12:13], v[112:113], v[104:105] op_sel_hi:[0,1,1] neg_lo:[0,0,1] neg_hi:[0,0,1]
    v_pk_fma_f32 v[106:107], v[12:13], v[114:115], v[106:107] op_sel_hi:[0,1,1] neg_lo:[0,0,1] neg_hi:[0,0,1]
    v_pk_fma_f32 v[108:109], v[12:13], v[116:117], v[108:109] op_sel_hi:[0,1,1] neg_lo:[0,0,1] neg_hi:[0,0,1]
    v_pk_fma_f32 v[110:111], v[12:13], v[118:119], v[110:111] op_sel_hi:[0,1,1] neg_lo:[0,0,1] neg_hi:[0,0,1]
    v_cvt_pk_bf16_f32 v36, v112, v113
    v_cvt_pk_bf16_f32 v37, v114, v115
    v_cvt_pk_bf16_f32 v38, v116, v117
    s_mov_b32 exec_hi, 0x00ffffff
    buffer_load_dwordx4 v3, s[4:7], s59 offen nt lds
    s_mov_b32 exec_hi, -1
    s_mov_b32 s60, 2162744
    s_load_dword s54, s[8:9], s60
    s_lshl_b32 s60, s58, 2
    s_add_u32 s60, s60, 2162688
    s_load_dword s62, s[8:9], s60
    s_add_u32 s60, s60, 28
    s_load_dword s63, s[8:9], s60
    s_cmp_lg_u32 s48, 3
    s_cbranch_scc1 L_A1
    s_mov_b32 exec_hi, 0x00ffffff
    s_mov_b32 m0, 33280
    s_nop 0
    global_load_lds_dwordx4 v3, s[40:41]
    s_mov_b32 exec_hi, -1
L_A1:
    s_setprio 2
    s_and_b32 s52, s2, 7
    s_lshl_b32 s52, s52, 2
    s_bfe_u32 s53, s2, 0x20003
    s_or_b32 s52, s52, s53
    s_lshr_b32 s53, s2, 5
    s_mov_b32 s12, s18
    s_mov_b32 s13, s19
    s_mov_b32 s14, 921600
    s_mov_b32 s15, 0x20000
    s_mov_b32 s22, 921600
    s_mov_b32 s23, 0x20000
    v_lshrrev_b32 v2, 2, v1
    v_mul_u32_u24 v2, 14400, v2
    v_and_b32 v11, 48, v3
    v_add_u32 v2, v2, v11
    s_mul_i32 s55, s52, 450
    s_and_b32 s55, s55, -4
    s_mul_i32 s56, s53, 60
    s_add_u32 s55, s55, s56
    s_mul_i32 s56, s48, 230400
    s_add_u32 s3, s55, s56
    s_lshl_b32 s61, s48, 11
    s_add_u32 m0, s61, 43520
    v_cvt_pk_bf16_f32 v39, v118, v119
    v_pk_fma_f32 v[112:113], v[12:13], v[104:105], v[112:113] op_sel_hi:[0,1,1] neg_lo:[0,0,1] neg_hi:[0,0,1]
    v_pk_fma_f32 v[114:115], v[12:13], v[106:107], v[114:115] op_sel_hi:[0,1,1] neg_lo:[0,0,1] neg_hi:[0,0,1]
    v_pk_fma_f32 v[116:117], v[12:13], v[108:109], v[116:117] op_sel_hi:[0,1,1] neg_lo:[0,0,1] neg_hi:[0,0,1]
    v_pk_fma_f32 v[118:119], v[12:13], v[110:111], v[118:119] op_sel_hi:[0,1,1] neg_lo:[0,0,1] neg_hi:[0,0,1]
    v_cvt_pk_bf16_f32 v40, v104, v105
    v_cvt_pk_bf16_f32 v41, v106, v107
    v_cvt_pk_bf16_f32 v42, v108, v109
    v_cvt_pk_bf16_f32 v43, v110, v111
    v_pk_fma_f32 v[104:105], v[12:13], v[112:113], v[104:105] op_sel_hi:[0,1,1] neg_lo:[0,0,1] neg_hi:[0,0,1]
    v_pk_fma_f32 v[106:107], v[12:13], v[114:115], v[106:107] op_sel_hi:[0,1,1] neg_lo:[0,0,1] neg_hi:[0,0,1]
    v_pk_fma_f32 v[108:109], v[12:13], v[116:117], v[108:109] op_sel_hi:[0,1,1] neg_lo:[0,0,1] neg_hi:[0,0,1]
    v_pk_fma_f32 v[110:111], v[12:13], v[118:119], v[110:111] op_sel_hi:[0,1,1] neg_lo:[0,0,1] neg_hi:[0,0,1]
    v_cvt_pk_bf16_f32 v44, v112, v113
    v_cvt_pk_bf16_f32 v45, v114, v115
    v_cvt_pk_bf16_f32 v46, v116, v117
    v_cvt_pk_bf16_f32 v47, v118, v119
    v_pk_fma_f32 v[112:113], v[12:13], v[104:105], v[112:113] op_sel_hi:[0,1,1] neg_lo:[0,0,1] neg_hi:[0,0,1]
    v_pk_fma_f32 v[114:115], v[12:13], v[106:107], v[114:115] op_sel_hi:[0,1,1] neg_lo:[0,0,1] neg_hi:[0,0,1]
    v_pk_fma_f32 v[116:117], v[12:13], v[108:109], v[116:117] op_sel_hi:[0,1,1] neg_lo:[0,0,1] neg_hi:[0,0,1]
    v_pk_fma_f32 v[118:119], v[12:13], v[110:111], v[118:119] op_sel_hi:[0,1,1] neg_lo:[0,0,1] neg_hi:[0,0,1]
    v_cvt_pk_bf16_f32 v48, v104, v105
    v_cvt_pk_bf16_f32 v49, v106, v107
    v_cvt_pk_bf16_f32 v50, v108, v109
    v_cvt_pk_bf16_f32 v51, v110, v111
    v_pk_fma_f32 v[104:105], v[12:13], v[112:113], v[104:105] op_sel_hi:[0,1,1] neg_lo:[0,0,1] neg_hi:[0,0,1]
    v_pk_fma_f32 v[106:107], v[12:13], v[114:115], v[106:107] op_sel_hi:[0,1,1] neg_lo:[0,0,1] neg_hi:[0,0,1]
    v_pk_fma_f32 v[108:109], v[12:13], v[116:117], v[108:109] op_sel_hi:[0,1,1] neg_lo:[0,0,1] neg_hi:[0,0,1]
    v_pk_fma_f32 v[110:111], v[12:13], v[118:119], v[110:111] op_sel_hi:[0,1,1] neg_lo:[0,0,1] neg_hi:[0,0,1]
    v_cvt_pk_bf16_f32 v52, v112, v113
    v_cvt_pk_bf16_f32 v53, v114, v115
    v_cvt_pk_bf16_f32 v54, v116, v117
    v_cvt_pk_bf16_f32 v55, v118, v119
    v_pk_fma_f32 v[112:113], v[12:13], v[104:105], v[112:113] op_sel_hi:[0,1,1] neg_lo:[0,0,1] neg_hi:[0,0,1]
    v_pk_fma_f32 v[114:115], v[12:13], v[106:107], v[114:115] op_sel_hi:[0,1,1] neg_lo:[0,0,1] neg_hi:[0,0,1]
    v_pk_fma_f32 v[116:117], v[12:13], v[108:109], v[116:117] op_sel_hi:[0,1,1] neg_lo:[0,0,1] neg_hi:[0,0,1]
    v_pk_fma_f32 v[118:119], v[12:13], v[110:111], v[118:119] op_sel_hi:[0,1,1] neg_lo:[0,0,1] neg_hi:[0,0,1]
    v_cvt_pk_bf16_f32 v56, v104, v105
    v_cvt_pk_bf16_f32 v57, v106, v107
    v_cvt_pk_bf16_f32 v58, v108, v109
    v_cvt_pk_bf16_f32 v59, v110, v111
    v_pk_fma_f32 v[104:105], v[12:13], v[112:113], v[104:105] op_sel_hi:[0,1,1] neg_lo:[0,0,1] neg_hi:[0,0,1]
    v_pk_fma_f32 v[106:107], v[12:13], v[114:115], v[106:107] op_sel_hi:[0,1,1] neg_lo:[0,0,1] neg_hi:[0,0,1]
    v_pk_fma_f32 v[108:109], v[12:13], v[116:117], v[108:109] op_sel_hi:[0,1,1] neg_lo:[0,0,1] neg_hi:[0,0,1]
    v_pk_fma_f32 v[110:111], v[12:13], v[118:119], v[110:111] op_sel_hi:[0,1,1] neg_lo:[0,0,1] neg_hi:[0,0,1]
    v_cvt_pk_bf16_f32 v60, v112, v113
    v_cvt_pk_bf16_f32 v61, v114, v115
    v_cvt_pk_bf16_f32 v62, v116, v117
    v_cvt_pk_bf16_f32 v63, v118, v119
    v_pk_fma_f32 v[112:113], v[12:13], v[104:105], v[112:113] op_sel_hi:[0,1,1] neg_lo:[0,0,1] neg_hi:[0,0,1]
    v_pk_fma_f32 v[114:115], v[12:13], v[106:107], v[114:115] op_sel_hi:[0,1,1] neg_lo:[0,0,1] neg_hi:[0,0,1]
    v_pk_fma_f32 v[116:117], v[12:13], v[108:109], v[116:117] op_sel_hi:[0,1,1] neg_lo:[0,0,1] neg_hi:[0,0,1]
    v_pk_fma_f32 v[118:119], v[12:13], v[110:111], v[118:119] op_sel_hi:[0,1,1] neg_lo:[0,0,1] neg_hi:[0,0,1]
    v_cvt_pk_bf16_f32 v64, v104, v105
    v_cvt_pk_bf16_f32 v65, v106, v107
    v_cvt_pk_bf16_f32 v66, v108, v109
    v_cvt_pk_bf16_f32 v67, v110, v111
    v_cvt_pk_bf16_f32 v68, v112, v113
    v_cvt_pk_bf16_f32 v69, v114, v115
    v_cvt_pk_bf16_f32 v70, v116, v117
    v_cvt_pk_bf16_f32 v71, v118, v119
    s_lshl_b32 s55, s48, 3
    v_lshrrev_b32 v9, 1, v7
    v_add_u32 v9, s55, v9
    v_cvt_f32_u32 v9, v9
    v_cvt_f32_u32 v15, s49
    v_mul_f32 v15, 0x3a000000, v15
    v_fmamk_f32 v10, v5, 0x3e000000, v15
    v_and_b32 v11, 1, v1
    v_cvt_f32_u32 v11, v11
    v_mul_f32 v13, 0x3e800000, v11
    v_sub_f32 v11, v13, v6
    v_fma_f32 v10, v9, v10, v11
    v_mul_f32 v9, 0x3d000000, v9
    v_fmamk_f32 v11, v9, 0x00000000, v10
    v_cos_f32 v104, v11
    v_fmamk_f32 v11, v9, 0x3f800000, v10
    v_cos_f32 v105, v11
    v_fmamk_f32 v11, v9, 0x40000000, v10
    v_cos_f32 v106, v11
    v_fmamk_f32 v11, v9, 0x40400000, v10
    v_cos_f32 v107, v11
    v_fmamk_f32 v11, v9, 0x41000000, v10
    v_cos_f32 v108, v11
    v_fmamk_f32 v11, v9, 0x41100000, v10
    v_cos_f32 v109, v11
    v_fmamk_f32 v11, v9, 0x41200000, v10
    v_cos_f32 v110, v11
    v_fmamk_f32 v11, v9, 0x41300000, v10
    v_cos_f32 v111, v11
    v_cvt_pk_bf16_f32 v112, v104, v105
    v_cvt_pk_bf16_f32 v113, v106, v107
    v_cvt_pk_bf16_f32 v114, v108, v109
    v_cvt_pk_bf16_f32 v115, v110, v111
    v_lshlrev_b32 v8, 4, v0
    ds_write_b128 v8, v[112:115] offset:29184
    v_and_b32 v4, 31, v1
    v_mul_u32_u24 v9, 912, v4
    v_lshl_add_u32 v9, v14, 4, v9
    s_setprio 3
    v_lshrrev_b32 v8, 1, v4
    v_and_b32 v8, 12, v8
    v_and_b32 v120, 2, v1
    v_bfe_u32 v6, v1, 2, 1
    v_add3_u32 v8, v8, v120, v6
    s_lshl_b32 s55, s48, 4
    v_add_u32 v8, s55, v8
    v_cvt_f32_u32 v8, v8
    v_mul_f32 v8, 0x3d000000, v8
    v_mul_f32 v124, 0.5, v5
    v_fma_f32 v124, v124, v8, v13
    v_add_f32 v125, v124, v8
    v_cos_f32 v120, v124
    v_sin_f32 v121, v124
    v_cos_f32 v122, v125
    v_sin_f32 v123, v125
    v_cos_f32 v124, v8
    v_mul_u32_u24 v6, 0x8000, v6
    v_lshl_or_b32 v6, v6, 16, v6
    v_add_f32 v124, v124, v124
    v_cvt_pk_bf16_f32 v152, v120, v121
    v_pk_fma_f32 v[120:121], v[124:125], v[122:123], v[120:121] op_sel_hi:[0,1,1] neg_lo:[0,0,1] neg_hi:[0,0,1]
    v_xor_b32 v128, v6, v152
    v_cvt_pk_bf16_f32 v153, v122, v123
    v_pk_fma_f32 v[122:123], v[124:125], v[120:121], v[122:123] op_sel_hi:[0,1,1] neg_lo:[0,0,1] neg_hi:[0,0,1]
    v_xor_b32 v129, v6, v153
    v_cvt_pk_bf16_f32 v154, v120, v121
    v_pk_fma_f32 v[120:121], v[124:125], v[122:123], v[120:121] op_sel_hi:[0,1,1] neg_lo:[0,0,1] neg_hi:[0,0,1]
    v_xor_b32 v130, v6, v154
    v_cvt_pk_bf16_f32 v155, v122, v123
    v_pk_fma_f32 v[122:123], v[124:125], v[120:121], v[122:123] op_sel_hi:[0,1,1] neg_lo:[0,0,1] neg_hi:[0,0,1]
    v_xor_b32 v131, v6, v155
    v_cvt_pk_bf16_f32 v156, v120, v121
    v_pk_fma_f32 v[120:121], v[124:125], v[122:123], v[120:121] op_sel_hi:[0,1,1] neg_lo:[0,0,1] neg_hi:[0,0,1]
    v_xor_b32 v132, v6, v156
    v_cvt_pk_bf16_f32 v157, v122, v123
    v_pk_fma_f32 v[122:123], v[124:125], v[120:121], v[122:123] op_sel_hi:[0,1,1] neg_lo:[0,0,1] neg_hi:[0,0,1]
    v_xor_b32 v133, v6, v157
    v_cvt_pk_bf16_f32 v158, v120, v121
    v_pk_fma_f32 v[120:121], v[124:125], v[122:123], v[120:121] op_sel_hi:[0,1,1] neg_lo:[0,0,1] neg_hi:[0,0,1]
    v_xor_b32 v134, v6, v158
    v_cvt_pk_bf16_f32 v159, v122, v123
    v_pk_fma_f32 v[122:123], v[124:125], v[120:121], v[122:123] op_sel_hi:[0,1,1] neg_lo:[0,0,1] neg_hi:[0,0,1]
    v_xor_b32 v135, v6, v159
    v_cvt_pk_bf16_f32 v160, v120, v121
    v_pk_fma_f32 v[120:121], v[124:125], v[122:123], v[120:121] op_sel_hi:[0,1,1] neg_lo:[0,0,1] neg_hi:[0,0,1]
    v_xor_b32 v136, v6, v160
    v_cvt_pk_bf16_f32 v161, v122, v123
    v_pk_fma_f32 v[122:123], v[124:125], v[120:121], v[122:123] op_sel_hi:[0,1,1] neg_lo:[0,0,1] neg_hi:[0,0,1]
    v_xor_b32 v137, v6, v161
    v_cvt_pk_bf16_f32 v162, v120, v121
    v_pk_fma_f32 v[120:121], v[124:125], v[122:123], v[120:121] op_sel_hi:[0,1,1] neg_lo:[0,0,1] neg_hi:[0,0,1]
    v_xor_b32 v138, v6, v162
    v_cvt_pk_bf16_f32 v163, v122, v123
    v_pk_fma_f32 v[122:123], v[124:125], v[120:121], v[122:123] op_sel_hi:[0,1,1] neg_lo:[0,0,1] neg_hi:[0,0,1]
    v_xor_b32 v139, v6, v163
    v_cvt_pk_bf16_f32 v164, v120, v121
    v_pk_fma_f32 v[120:121], v[124:125], v[122:123], v[120:121] op_sel_hi:[0,1,1] neg_lo:[0,0,1] neg_hi:[0,0,1]
    v_xor_b32 v140, v6, v164
    v_cvt_pk_bf16_f32 v165, v122, v123
    v_pk_fma_f32 v[122:123], v[124:125], v[120:121], v[122:123] op_sel_hi:[0,1,1] neg_lo:[0,0,1] neg_hi:[0,0,1]
    v_xor_b32 v141, v6, v165
    v_cvt_pk_bf16_f32 v166, v120, v121
    v_xor_b32 v142, v6, v166
    v_cvt_pk_bf16_f32 v167, v122, v123
    v_xor_b32 v143, v6, v167
    s_waitcnt vmcnt(0) lgkmcnt(0)
    s_barrier
    s_setprio 3
    ds_read_b128 v[104:107], v9 offset:0
    ds_read_b128 v[108:111], v9 offset:448
    ds_read_b128 v[112:115], v9 offset:32
    ds_read_b128 v[116:119], v9 offset:480
    ds_read_b128 v[120:123], v9 offset:64
    ds_read_b128 v[124:127], v9 offset:512
    s_waitcnt lgkmcnt(5)
    v_mfma_f32_32x32x16_bf16 v[72:87], v[104:107], v[16:19], 0
    ds_read_b128 v[104:107], v9 offset:96
    s_or_b32 s54, s54, 0x40004000
    s_add_u32 s54, s54, 1
    s_and_b32 s54, s54, 0xbfffbfff
    s_waitcnt lgkmcnt(5)
    v_mfma_f32_32x32x16_bf16 v[88:103], v[108:111], v[16:19], 0
    ds_read_b128 v[108:111], v9 offset:544
    v_mov_b32 v144, s54
    s_lshl_b32 s55, s57, 31
    s_or_b32 s55, s55, 1.0
    v_mov_b32 v10, s55
    s_waitcnt lgkmcnt(5)
    v_mfma_f32_32x32x16_bf16 v[72:87], v[112:115], v[20:23], v[72:87]
    ds_read_b128 v[112:115], v9 offset:128
    s_waitcnt lgkmcnt(5)
    v_mfma_f32_32x32x16_bf16 v[88:103], v[116:119], v[20:23], v[88:103]
    ds_read_b128 v[116:119], v9 offset:576
    s_waitcnt lgkmcnt(5)
    v_mfma_f32_32x32x16_bf16 v[72:87], v[120:123], v[24:27], v[72:87]
    ds_read_b128 v[120:123], v9 offset:160
    s_waitcnt lgkmcnt(5)
    v_mfma_f32_32x32x16_bf16 v[88:103], v[124:127], v[24:27], v[88:103]
    ds_read_b128 v[124:127], v9 offset:608
    v_and_b32 v11, 2, v1
    v_mul_u32_u24 v11, 0x4000, v11
    v_lshl_or_b32 v11, v11, 16, v11
    s_waitcnt lgkmcnt(5)
    v_mfma_f32_32x32x16_bf16 v[72:87], v[104:107], v[28:31], v[72:87]
    ds_read_b128 v[104:107], v9 offset:192
    s_waitcnt lgkmcnt(5)
    v_mfma_f32_32x32x16_bf16 v[88:103], v[108:111], v[28:31], v[88:103]
    ds_read_b128 v[108:111], v9 offset:640
    s_waitcnt lgkmcnt(5)
    v_mfma_f32_32x32x16_bf16 v[72:87], v[112:115], v[32:35], v[72:87]
    ds_read_b128 v[112:115], v9 offset:224
    v_lshrrev_b32 v12, 4, v1
    v_mul_u32_u24 v12, 133120, v12
    v_lshl_add_u32 v12, v7, 2, v12
    s_waitcnt lgkmcnt(5)
    v_mfma_f32_32x32x16_bf16 v[88:103], v[116:119], v[32:35], v[88:103]
    ds_read_b128 v[116:119], v9 offset:672
    s_waitcnt lgkmcnt(5)
    v_mfma_f32_32x32x16_bf16 v[72:87], v[120:123], v[36:39], v[72:87]
    ds_read_b128 v[16:19], v3 offset:29184
    ds_read_b128 v[120:123], v9 offset:256
    s_waitcnt lgkmcnt(6)
    v_mfma_f32_32x32x16_bf16 v[88:103], v[124:127], v[36:39], v[88:103]
    ds_read_b128 v[20:23], v3 offset:30208
    ds_read_b128 v[124:127], v9 offset:704
    s_waitcnt lgkmcnt(7)
    v_mfma_f32_32x32x16_bf16 v[72:87], v[104:107], v[40:43], v[72:87]
    ds_read_b128 v[24:27], v3 offset:31232
    ds_read_b128 v[104:107], v9 offset:288
    s_mul_i32 s55, s58, 8320
    s_lshl_b32 s56, s57, 6
    s_add_u32 s55, s55, s56
    s_lshl_b32 s56, s49, 7
    s_add_u32 s24, s55, s56
    s_waitcnt lgkmcnt(8)
    v_mfma_f32_32x32x16_bf16 v[88:103], v[108:111], v[40:43], v[88:103]
    ds_read_b128 v[28:31], v3 offset:32256
    ds_read_b128 v[108:111], v9 offset:736
    v_mov_b32 v145, v144
    s_add_u32 s25, s24, 66560
    s_waitcnt lgkmcnt(9)
    v_mfma_f32_32x32x16_bf16 v[72:87], v[112:115], v[44:47], v[72:87]
    ds_read_b128 v[112:115], v9 offset:320
    v_mov_b32 v146, v144
    s_add_u32 s26, s24, 532480
    s_waitcnt lgkmcnt(9)
    v_mfma_f32_32x32x16_bf16 v[88:103], v[116:119], v[44:47], v[88:103]
    ds_read_b128 v[116:119], v9 offset:768
    v_mov_b32 v147, v144
    s_add_u32 s27, s24, 599040
    s_waitcnt lgkmcnt(8)
    v_mfma_f32_32x32x16_bf16 v[72:87], v[120:123], v[48:51], v[72:87]
    ds_read_b128 v[120:123], v9 offset:352
    v_mov_b32 v148, v144
    s_add_u32 s28, s24, 1064960
    s_waitcnt lgkmcnt(7)
    v_mfma_f32_32x32x16_bf16 v[88:103], v[124:127], v[48:51], v[88:103]
    ds_read_b128 v[124:127], v9 offset:800
    v_mov_b32 v149, v144
    s_add_u32 s29, s24, 1131520
    s_waitcnt lgkmcnt(6)
    v_mfma_f32_32x32x16_bf16 v[72:87], v[104:107], v[52:55], v[72:87]
    ds_read_b128 v[104:107], v9 offset:384
    v_mov_b32 v150, v144
    s_add_u32 s30, s24, 1597440
    s_waitcnt lgkmcnt(5)
    v_mfma_f32_32x32x16_bf16 v[88:103], v[108:111], v[52:55], v[88:103]
    ds_read_b128 v[108:111], v9 offset:832
    v_mov_b32 v151, v144
    s_add_u32 s31, s24, 1664000
    s_waitcnt lgkmcnt(5)
    v_mfma_f32_32x32x16_bf16 v[72:87], v[112:115], v[56:59], v[72:87]
    ds_read_b128 v[112:115], v9 offset:416
    v_xor_b32 v32, v11, v16
    v_xor_b32 v33, v11, v17
    v_xor_b32 v34, v11, v18
    v_xor_b32 v35, v11, v19
    s_waitcnt lgkmcnt(5)
    v_mfma_f32_32x32x16_bf16 v[88:103], v[116:119], v[56:59], v[88:103]
    ds_read_b128 v[116:119], v9 offset:864
    v_xor_b32 v36, v11, v20
    v_xor_b32 v37, v11, v21
    v_xor_b32 v38, v11, v22
    v_xor_b32 v39, v11, v23
    s_waitcnt lgkmcnt(5)
    v_mfma_f32_32x32x16_bf16 v[72:87], v[120:123], v[60:63], v[72:87]
    v_xor_b32 v40, v11, v24
    v_xor_b32 v41, v11, v25
    v_xor_b32 v42, v11, v26
    v_xor_b32 v43, v11, v27
    s_waitcnt lgkmcnt(4)
    v_mfma_f32_32x32x16_bf16 v[88:103], v[124:127], v[60:63], v[88:103]
    v_xor_b32 v44, v11, v28
    v_xor_b32 v45, v11, v29
    v_xor_b32 v46, v11, v30
    v_xor_b32 v47, v11, v31
    s_waitcnt lgkmcnt(3)
    v_mfma_f32_32x32x16_bf16 v[72:87], v[104:107], v[64:67], v[72:87]
    s_waitcnt lgkmcnt(2)
    v_mfma_f32_32x32x16_bf16 v[88:103], v[108:111], v[64:67], v[88:103]
    s_waitcnt lgkmcnt(1)
    v_mfma_f32_32x32x16_bf16 v[72:87], v[112:115], v[68:71], v[72:87]
    s_waitcnt lgkmcnt(0)
    v_mfma_f32_32x32x16_bf16 v[88:103], v[116:119], v[68:71], v[88:103]
    s_setprio 3
    s_nop 10
    v_fmac_f32 v72, v10, v88
    v_fmac_f32 v73, v10, v89
    v_cvt_pk_bf16_f32 v48, v72, v73
    v_fmac_f32 v74, v10, v90
    v_fmac_f32 v75, v10, v91
    v_cvt_pk_bf16_f32 v49, v74, v75
    v_fmac_f32 v76, v10, v92
    v_fmac_f32 v77, v10, v93
    v_cvt_pk_bf16_f32 v50, v76, v77
    v_fmac_f32 v78, v10, v94
    v_fmac_f32 v79, v10, v95
    v_cvt_pk_bf16_f32 v51, v78, v79
    v_fmac_f32 v80, v10, v96
    v_fmac_f32 v81, v10, v97
    v_cvt_pk_bf16_f32 v52, v80, v81
    v_mfma_f32_16x16x32_bf16 v[104:107], v[16:19], v[48:51], 0
    v_fmac_f32 v82, v10, v98
    v_fmac_f32 v83, v10, v99
    v_cvt_pk_bf16_f32 v53, v82, v83
    v_mfma_f32_16x16x32_bf16 v[108:111], v[20:23], v[48:51], 0
    v_fmac_f32 v84, v10, v100
    v_fmac_f32 v85, v10, v101
    v_cvt_pk_bf16_f32 v54, v84, v85
    v_mfma_f32_16x16x32_bf16 v[112:115], v[24:27], v[48:51], 0
    v_fmac_f32 v86, v10, v102
    v_fmac_f32 v87, v10, v103
    v_cvt_pk_bf16_f32 v55, v86, v87
    v_mfma_f32_16x16x32_bf16 v[116:119], v[28:31], v[48:51], 0
    s_nop 0
    v_mfma_f32_16x16x32_bf16 v[104:107], v[32:35], v[52:55], v[104:107]
    v_mfma_f32_16x16x32_bf16 v[108:111], v[36:39], v[52:55], v[108:111]
    v_mfma_f32_16x16x32_bf16 v[112:115], v[40:43], v[52:55], v[112:115]
    v_mfma_f32_16x16x32_bf16 v[116:119], v[44:47], v[52:55], v[116:119]
    s_mov_b32 exec_lo, 2147450879
    s_mov_b32 exec_hi, 2147450879
    s_nop 2
    v_cvt_pk_bf16_f32 v144, v104, v105
    v_cvt_pk_bf16_f32 v145, v106, v107
    v_cvt_pk_bf16_f32 v146, v108, v109
    v_cvt_pk_bf16_f32 v147, v110, v111
    v_cvt_pk_bf16_f32 v148, v112, v113
    v_cvt_pk_bf16_f32 v149, v114, v115
    v_cvt_pk_bf16_f32 v150, v116, v117
    v_cvt_pk_bf16_f32 v151, v118, v119
    s_mov_b64 exec, -1
    buffer_store_dword v144, v12, s[8:11], s24 offen sc1
    buffer_store_dword v145, v12, s[8:11], s25 offen sc1
    buffer_store_dword v146, v12, s[8:11], s26 offen sc1
    buffer_store_dword v147, v12, s[8:11], s27 offen sc1
    buffer_store_dword v148, v12, s[8:11], s28 offen sc1
    buffer_store_dword v149, v12, s[8:11], s29 offen sc1
    buffer_store_dword v150, v12, s[8:11], s30 offen sc1
    buffer_store_dword v151, v12, s[8:11], s31 offen sc1
    s_setprio 0
    s_mul_i32 s55, s48, 224
    v_add_u32 v9, s55, v9
    v_lshl_add_u32 v10, v14, 4, s55
    ds_read_b128 v[16:19], v9 offset:0
    ds_read_b128 v[44:47], v10 offset:33280
    ds_read_b128 v[20:23], v9 offset:32
    ds_read_b128 v[48:51], v10 offset:33312
    ds_read_b128 v[24:27], v9 offset:64
    ds_read_b128 v[52:55], v10 offset:33344
    ds_read_b128 v[28:31], v9 offset:96
    ds_read_b128 v[56:59], v10 offset:33376
    ds_read_b128 v[32:35], v9 offset:128
    ds_read_b128 v[60:63], v10 offset:33408
    ds_read_b128 v[36:39], v9 offset:160
    ds_read_b128 v[64:67], v10 offset:33440
    ds_read_b128 v[40:43], v9 offset:192
    ds_read_b128 v[68:71], v10 offset:33472
    s_waitcnt lgkmcnt(12)
    v_mfma_f32_32x32x16_bf16 v[112:127], v[44:47], v[16:19], 0
    s_waitcnt lgkmcnt(10)
    v_mfma_f32_32x32x16_bf16 v[112:127], v[48:51], v[20:23], v[112:127]
    s_waitcnt lgkmcnt(8)
    v_mfma_f32_32x32x16_bf16 v[112:127], v[52:55], v[24:27], v[112:127]
    s_waitcnt lgkmcnt(6)
    v_mfma_f32_32x32x16_bf16 v[112:127], v[56:59], v[28:31], v[112:127]
    s_waitcnt lgkmcnt(4)
    v_mfma_f32_32x32x16_bf16 v[112:127], v[60:63], v[32:35], v[112:127]
    s_waitcnt lgkmcnt(2)
    v_mfma_f32_32x32x16_bf16 v[112:127], v[64:67], v[36:39], v[112:127]
    s_waitcnt lgkmcnt(0)
    v_mfma_f32_32x32x16_bf16 v[112:127], v[68:71], v[40:43], v[112:127]
    v_bfe_u32 v13, v1, 4, 1
    v_lshl_add_u32 v13, v7, 1, v13
    s_and_b32 s55, s52, 1
    s_lshl_b32 s55, s55, 1
    s_add_u32 s55, s55, s61
    v_lshl_add_u32 v6, v13, 1, s55
    v_lshl_add_u32 v6, v14, 6, v6
    s_lshl_b32 s55, s52, 3
    s_add_u32 s55, s55, s53
    s_mul_i32 s55, s55, 8320
    s_add_u32 s55, s55, s61
    v_add_u32 v11, s61, v3
    s_add_u32 s56, s61, 35328
    v_or_b32 v9, 60, v11
    v_mov_b32 v127, v2
    s_mov_b32 s47, s3
    v_lshlrev_b32 v2, 2, v1
    s_or_b32 s3, s54, 0x40004000
    s_add_u32 s3, s3, 1
    s_and_b32 s3, s3, 0xbfffbfff
    v_mov_b32 v144, s3
    v_mov_b32 v145, v144
    v_mov_b32 v146, v144
    v_mov_b32 v147, v144
    v_mov_b32 v148, v144
    v_mov_b32 v149, v144
    v_mov_b32 v150, v144
    v_mov_b32 v151, v144
    v_lshlrev_b32 v10, 2, v0
    ds_write_b32 v10, v112 offset:34304
    s_add_u32 s60, s53, 1
    s_and_b32 s60, s60, 6
    s_cmp_lg_u32 s60, 0
    s_cbranch_scc1 L_A3
    s_mul_i32 s59, s53, 30
    v_add_u32 v8, s59, v13
    v_mov_b32 v10, 1.0
    v_cmp_eq_u32 vcc, 0, v8
    s_nop 1
    v_cndmask_b32 v10, v10, 0.5, vcc
    v_cmp_eq_u32 vcc, 224, v8
    s_nop 1
    v_cndmask_b32 v10, v10, 0.5, vcc
    v_cmp_lt_u32 vcc, 224, v8
    s_nop 1
    v_cndmask_b32 v10, v10, 0, vcc
L_A3:
    s_setprio 3
    s_mov_b32 m0, s56
    s_mov_b32 s59, 0
    s_waitcnt vmcnt(0)
    s_setprio 0
    s_lshl_b32 s46, s57, 4
    v_xor_b32 v8, s46, v4
    v_bfe_u32 v12, v8, 2, 1
    v_bfe_u32 v13, v8, 3, 1
    v_and_b32 v8, 19, v8
    v_lshl_add_u32 v8, v12, 3, v8
    v_lshl_add_u32 v8, v13, 2, v8
    s_lshl_b32 s46, s58, 5
    v_add_u32 v8, s46, v8
    v_cvt_f32_u32 v8, v8
    v_mul_f32 v8, 0x3b124925, v8
    v_lshl_add_u32 v12, v14, 3, s57
    v_cvt_f32_u32 v12, v12
    v_mul_f32 v12, v12, v8
    v_mul_f32 v5, 0x41f00000, v8
    v_cos_f32 v5, v5
    v_fmamk_f32 v13, v8, 0x00000000, v12
    v_fmamk_f32 v7, v8, 0x41f00000, v12
    v_cos_f32 v80, v13
    v_sin_f32 v88, v13
    v_cos_f32 v96, v7
    v_sin_f32 v104, v7
    v_fmamk_f32 v13, v8, 0x40000000, v12
    v_fmamk_f32 v7, v8, 0x42000000, v12
    v_cos_f32 v81, v13
    v_sin_f32 v89, v13
    v_cos_f32 v97, v7
    v_sin_f32 v105, v7
    v_fmamk_f32 v13, v8, 0x40800000, v12
    v_fmamk_f32 v7, v8, 0x42080000, v12
    v_cos_f32 v82, v13
    v_sin_f32 v90, v13
    v_cos_f32 v98, v7
    v_sin_f32 v106, v7
    v_fmamk_f32 v13, v8, 0x40c00000, v12
    v_fmamk_f32 v7, v8, 0x42100000, v12
    v_cos_f32 v83, v13
    v_sin_f32 v91, v13
    v_cos_f32 v99, v7
    v_sin_f32 v107, v7
    v_fmamk_f32 v13, v8, 0x41800000, v12
    v_fmamk_f32 v7, v8, 0x42380000, v12
    v_cos_f32 v84, v13
    v_sin_f32 v92, v13
    v_cos_f32 v100, v7
    v_sin_f32 v108, v7
    v_fmamk_f32 v13, v8, 0x41900000, v12
    v_fmamk_f32 v7, v8, 0x42400000, v12
    v_cos_f32 v85, v13
    v_sin_f32 v93, v13
    v_cos_f32 v101, v7
    v_sin_f32 v109, v7
    v_fmamk_f32 v13, v8, 0x41a00000, v12
    v_fmamk_f32 v7, v8, 0x42480000, v12
    v_cos_f32 v86, v13
    v_sin_f32 v94, v13
    v_cos_f32 v102, v7
    v_sin_f32 v110, v7
    v_fmamk_f32 v13, v8, 0x41b00000, v12
    v_fmamk_f32 v7, v8, 0x42500000, v12
    v_cos_f32 v87, v13
    v_sin_f32 v95, v13
    v_cos_f32 v103, v7
    v_sin_f32 v111, v7
    v_add_f32 v5, v5, v5
    s_mov_b32 exec_lo, 0
    v_mov_b32 v87, 0
    v_mov_b32 v95, 0
    v_mov_b32 v103, 0
    v_mov_b32 v111, 0
    s_mov_b32 exec_lo, -1
    v_cvt_pk_bf16_f32 v16, v80, v81
    v_cvt_pk_bf16_f32 v17, v82, v83
    v_cvt_pk_bf16_f32 v18, v84, v85
    v_cvt_pk_bf16_f32 v19, v86, v87
    v_cvt_pk_bf16_f32 v20, v88, v89
    v_cvt_pk_bf16_f32 v21, v90, v91
    v_cvt_pk_bf16_f32 v22, v92, v93
    v_cvt_pk_bf16_f32 v23, v94, v95
    v_fma_f32 v80, v5, v96, -v80
    v_fma_f32 v81, v5, v97, -v81
    v_fma_f32 v82, v5, v98, -v82
    v_fma_f32 v83, v5, v99, -v83
    v_fma_f32 v84, v5, v100, -v84
    v_fma_f32 v85, v5, v101, -v85
    v_fma_f32 v86, v5, v102, -v86
    v_fma_f32 v87, v5, v103, -v87
    v_fma_f32 v88, v5, v104, -v88
    v_fma_f32 v89, v5, v105, -v89
    v_fma_f32 v90, v5, v106, -v90
    v_fma_f32 v91, v5, v107, -v91
    v_fma_f32 v92, v5, v108, -v92
    v_fma_f32 v93, v5, v109, -v93
    v_fma_f32 v94, v5, v110, -v94
    v_fma_f32 v95, v5, v111, -v95
    buffer_load_dwordx4 v3, s[8:11], s55 offen sc1 lds
    buffer_load_dwordx4 v3, s[8:11], s55 offen offset:1024 sc1 lds
    v_cvt_pk_bf16_f32 v24, v96, v97
    v_cvt_pk_bf16_f32 v25, v98, v99
    v_cvt_pk_bf16_f32 v26, v100, v101
    v_cvt_pk_bf16_f32 v27, v102, v103
    v_cvt_pk_bf16_f32 v28, v104, v105
    v_cvt_pk_bf16_f32 v29, v106, v107
    v_cvt_pk_bf16_f32 v30, v108, v109
    v_cvt_pk_bf16_f32 v31, v110, v111
    v_fma_f32 v96, v5, v80, -v96
    v_fma_f32 v97, v5, v81, -v97
    v_fma_f32 v98, v5, v82, -v98
    v_fma_f32 v99, v5, v83, -v99
    v_fma_f32 v100, v5, v84, -v100
    v_fma_f32 v101, v5, v85, -v101
    v_fma_f32 v102, v5, v86, -v102
    v_fma_f32 v103, v5, v87, -v103
    v_fma_f32 v104, v5, v88, -v104
    v_fma_f32 v105, v5, v89, -v105
    v_fma_f32 v106, v5, v90, -v106
    v_fma_f32 v107, v5, v91, -v107
    v_fma_f32 v108, v5, v92, -v108
    v_fma_f32 v109, v5, v93, -v109
    v_fma_f32 v110, v5, v94, -v110
    v_fma_f32 v111, v5, v95, -v111
    v_cvt_pk_bf16_f32 v32, v80, v81
    v_cvt_pk_bf16_f32 v33, v82, v83
    v_cvt_pk_bf16_f32 v34, v84, v85
    v_cvt_pk_bf16_f32 v35, v86, v87
    v_cvt_pk_bf16_f32 v36, v88, v89
    v_cvt_pk_bf16_f32 v37, v90, v91
    v_cvt_pk_bf16_f32 v38, v92, v93
    v_cvt_pk_bf16_f32 v39, v94, v95
    v_fma_f32 v80, v5, v96, -v80
    v_fma_f32 v81, v5, v97, -v81
    v_fma_f32 v82, v5, v98, -v82
    v_fma_f32 v83, v5, v99, -v83
    v_fma_f32 v84, v5, v100, -v84
    v_fma_f32 v85, v5, v101, -v85
    v_fma_f32 v86, v5, v102, -v86
    v_fma_f32 v87, v5, v103, -v87
    v_fma_f32 v88, v5, v104, -v88
    v_fma_f32 v89, v5, v105, -v89
    v_fma_f32 v90, v5, v106, -v90
    v_fma_f32 v91, v5, v107, -v91
    v_fma_f32 v92, v5, v108, -v92
    v_fma_f32 v93, v5, v109, -v93
    v_fma_f32 v94, v5, v110, -v94
    v_fma_f32 v95, v5, v111, -v95
    s_add_u32 m0, s61, 43520
    s_nop 0
    buffer_load_dwordx4 v127, s[12:15], s47 offen nt lds
    s_add_u32 m0, m0, 1024
    s_nop 0
    buffer_load_dwordx4 v127, s[20:23], s47 offen nt lds
    s_mov_b32 m0, s56
    v_cvt_pk_bf16_f32 v40, v96, v97
    v_cvt_pk_bf16_f32 v41, v98, v99
    v_cvt_pk_bf16_f32 v42, v100, v101
    v_cvt_pk_bf16_f32 v43, v102, v103
    v_cvt_pk_bf16_f32 v44, v104, v105
    v_cvt_pk_bf16_f32 v45, v106, v107
    v_cvt_pk_bf16_f32 v46, v108, v109
    v_cvt_pk_bf16_f32 v47, v110, v111
    v_fma_f32 v96, v5, v80, -v96
    v_fma_f32 v97, v5, v81, -v97
    v_fma_f32 v98, v5, v82, -v98
    v_fma_f32 v99, v5, v83, -v99
    v_fma_f32 v100, v5, v84, -v100
    v_fma_f32 v101, v5, v85, -v101
    v_fma_f32 v102, v5, v86, -v102
    v_fma_f32 v103, v5, v87, -v103
    v_fma_f32 v104, v5, v88, -v104
    v_fma_f32 v105, v5, v89, -v105
    v_fma_f32 v106, v5, v90, -v106
    v_fma_f32 v107, v5, v91, -v107
    v_fma_f32 v108, v5, v92, -v108
    v_fma_f32 v109, v5, v93, -v109
    v_fma_f32 v110, v5, v94, -v110
    v_fma_f32 v111, v5, v95, -v111
    v_cvt_pk_bf16_f32 v48, v80, v81
    v_cvt_pk_bf16_f32 v49, v82, v83
    v_cvt_pk_bf16_f32 v50, v84, v85
    v_cvt_pk_bf16_f32 v51, v86, v87
    v_cvt_pk_bf16_f32 v52, v88, v89
    v_cvt_pk_bf16_f32 v53, v90, v91
    v_cvt_pk_bf16_f32 v54, v92, v93
    v_cvt_pk_bf16_f32 v55, v94, v95
    v_fma_f32 v80, v5, v96, -v80
    v_fma_f32 v81, v5, v97, -v81
    v_fma_f32 v82, v5, v98, -v82
    v_fma_f32 v83, v5, v99, -v83
    v_fma_f32 v84, v5, v100, -v84
    v_fma_f32 v85, v5, v101, -v85
    v_fma_f32 v86, v5, v102, -v86
    v_fma_f32 v87, v5, v103, -v87
    v_fma_f32 v88, v5, v104, -v88
    v_fma_f32 v89, v5, v105, -v89
    v_fma_f32 v90, v5, v106, -v90
    v_fma_f32 v91, v5, v107, -v91
    v_fma_f32 v92, v5, v108, -v92
    v_fma_f32 v93, v5, v109, -v93
    v_fma_f32 v94, v5, v110, -v94
    v_fma_f32 v95, v5, v111, -v95
    v_cvt_pk_bf16_f32 v56, v96, v97
    v_cvt_pk_bf16_f32 v57, v98, v99
    v_cvt_pk_bf16_f32 v58, v100, v101
    v_cvt_pk_bf16_f32 v59, v102, v103
    v_cvt_pk_bf16_f32 v60, v104, v105
    v_cvt_pk_bf16_f32 v61, v106, v107
    v_cvt_pk_bf16_f32 v62, v108, v109
    v_cvt_pk_bf16_f32 v63, v110, v111
    v_fma_f32 v96, v5, v80, -v96
    v_fma_f32 v97, v5, v81, -v97
    v_fma_f32 v98, v5, v82, -v98
    v_fma_f32 v99, v5, v83, -v99
    v_fma_f32 v100, v5, v84, -v100
    v_fma_f32 v101, v5, v85, -v101
    v_fma_f32 v102, v5, v86, -v102
    v_fma_f32 v103, v5, v87, -v103
    v_fma_f32 v104, v5, v88, -v104
    v_fma_f32 v105, v5, v89, -v105
    v_fma_f32 v106, v5, v90, -v106
    v_fma_f32 v107, v5, v91, -v107
    v_fma_f32 v108, v5, v92, -v108
    v_fma_f32 v109, v5, v93, -v109
    v_fma_f32 v110, v5, v94, -v110
    v_fma_f32 v111, v5, v95, -v111
    v_cvt_pk_bf16_f32 v64, v80, v81
    v_cvt_pk_bf16_f32 v65, v82, v83
    v_cvt_pk_bf16_f32 v66, v84, v85
    v_cvt_pk_bf16_f32 v67, v86, v87
    v_cvt_pk_bf16_f32 v68, v88, v89
    v_cvt_pk_bf16_f32 v69, v90, v91
    v_cvt_pk_bf16_f32 v70, v92, v93
    v_cvt_pk_bf16_f32 v71, v94, v95
    v_cvt_pk_bf16_f32 v72, v96, v97
    v_cvt_pk_bf16_f32 v73, v98, v99
    v_cvt_pk_bf16_f32 v74, v100, v101
    v_cvt_pk_bf16_f32 v75, v102, v103
    v_cvt_pk_bf16_f32 v76, v104, v105
    v_cvt_pk_bf16_f32 v77, v106, v107
    v_cvt_pk_bf16_f32 v78, v108, v109
    v_cvt_pk_bf16_f32 v79, v110, v111
    s_setprio 3
    s_waitcnt vmcnt(2)
L_ZP:
    ds_read2st64_b32 v[12:13], v9 offset0:138 offset1:142
    s_add_u32 s59, s59, 1
    s_waitcnt lgkmcnt(0)
    v_cmp_ne_u32 vcc, s54, v12
    v_cmp_ne_u32 s[0:1], s54, v13
    s_nop 0
    s_or_b64 s[44:45], vcc, s[0:1]
    s_cbranch_scc0 L_ZD
    s_cmp_gt_u32 s59, 4000
    s_cbranch_scc1 L_ZD
    s_sleep 2
    s_mov_b64 exec, vcc
    s_cbranch_execz L_ZP1
    buffer_load_dwordx4 v3, s[8:11], s55 offen sc1 lds
L_ZP1:
    s_mov_b64 exec, s[0:1]
    s_cbranch_execz L_ZP2
    buffer_load_dwordx4 v3, s[8:11], s55 offen offset:1024 sc1 lds
L_ZP2:
    s_mov_b64 exec, -1
    s_waitcnt vmcnt(0)
    s_branch L_ZP
L_ZD:
    s_barrier
    ds_read2st64_b32 v[80:81], v2 offset0:138 offset1:139
    ds_read2st64_b32 v[82:83], v2 offset0:140 offset1:141
    ds_read2st64_b32 v[84:85], v2 offset0:142 offset1:143
    ds_read2st64_b32 v[86:87], v2 offset0:144 offset1:145
    ds_read2st64_b32 v[88:89], v2 offset0:146 offset1:147
    ds_read2st64_b32 v[90:91], v2 offset0:148 offset1:149
    ds_read2st64_b32 v[92:93], v2 offset0:150 offset1:151
    ds_read2st64_b32 v[94:95], v2 offset0:152 offset1:153
    s_waitcnt lgkmcnt(6)
    v_mfma_f32_32x32x16_bf16 v[96:111], v[152:155], v[80:83], 0
    ds_read2st64_b32 v[80:81], v2 offset0:154 offset1:155
    ds_read2st64_b32 v[82:83], v2 offset0:156 offset1:157
    s_waitcnt lgkmcnt(6)
    v_mfma_f32_32x32x16_bf16 v[96:111], v[156:159], v[84:87], v[96:111]
    ds_read2st64_b32 v[84:85], v2 offset0:158 offset1:159
    ds_read2st64_b32 v[86:87], v2 offset0:160 offset1:161
    s_waitcnt lgkmcnt(6)
    v_mfma_f32_32x32x16_bf16 v[96:111], v[160:163], v[88:91], v[96:111]
    ds_read2st64_b32 v[88:89], v2 offset0:162 offset1:163
    ds_read2st64_b32 v[90:91], v2 offset0:164 offset1:165
    s_waitcnt lgkmcnt(6)
    v_mfma_f32_32x32x16_bf16 v[96:111], v[164:167], v[92:95], v[96:111]
    ds_read2st64_b32 v[92:93], v2 offset0:166 offset1:167
    ds_read2st64_b32 v[94:95], v2 offset0:168 offset1:169
    s_waitcnt lgkmcnt(6)
    v_mfma_f32_32x32x16_bf16 v[96:111], v[128:131], v[80:83], v[96:111]
    s_waitcnt lgkmcnt(4)
    v_mfma_f32_32x32x16_bf16 v[96:111], v[132:135], v[84:87], v[96:111]
    s_waitcnt lgkmcnt(2)
    v_mfma_f32_32x32x16_bf16 v[96:111], v[136:139], v[88:91], v[96:111]
    s_waitcnt lgkmcnt(0)
    v_mfma_f32_32x32x16_bf16 v[96:111], v[140:143], v[92:95], v[96:111]
    s_waitcnt vmcnt(0)
    ds_read_u16_d16_hi v112, v6 offset:43520
    ds_read_u16_d16_hi v113, v6 offset:44544
    ds_read_u16_d16_hi v114, v6 offset:43648
    ds_read_u16_d16_hi v115, v6 offset:44672
    ds_read_u16_d16_hi v116, v6 offset:43776
    ds_read_u16_d16_hi v117, v6 offset:44800
    ds_read_u16_d16_hi v118, v6 offset:43904
    ds_read_u16_d16_hi v119, v6 offset:44928
    ds_read_u16_d16_hi v120, v6 offset:44032
    ds_read_u16_d16_hi v121, v6 offset:45056
    ds_read_u16_d16_hi v122, v6 offset:44160
    ds_read_u16_d16_hi v123, v6 offset:45184
    ds_read_u16_d16_hi v124, v6 offset:44288
    ds_read_u16_d16_hi v125, v6 offset:45312
    ds_read_u16_d16_hi v126, v6 offset:44416
    ds_read_u16_d16_hi v127, v6 offset:45440
    s_cmp_lg_u32 s60, 0
    s_cbranch_scc1 L_A4
    v_mul_f32 v96, v10, v96
    v_mul_f32 v97, v10, v97
    v_mul_f32 v98, v10, v98
    v_mul_f32 v99, v10, v99
    v_mul_f32 v100, v10, v100
    v_mul_f32 v101, v10, v101
    v_mul_f32 v102, v10, v102
    v_mul_f32 v103, v10, v103
    v_mul_f32 v104, v10, v104
    v_mul_f32 v105, v10, v105
    v_mul_f32 v106, v10, v106
    v_mul_f32 v107, v10, v107
    v_mul_f32 v108, v10, v108
    v_mul_f32 v109, v10, v109
    v_mul_f32 v110, v10, v110
    v_mul_f32 v111, v10, v111
L_A4:
    s_waitcnt lgkmcnt(12)
    v_mul_f32 v88, v96, v112
    v_mul_f32 v89, v96, v113
    v_fma_f32 v88, -v97, v113, v88
    v_fma_f32 v89, v97, v112, v89
    v_cvt_pk_bf16_f32 v80, v88, -v89
    v_mul_f32 v90, v98, v114
    v_mul_f32 v91, v98, v115
    v_fma_f32 v90, -v99, v115, v90
    v_fma_f32 v91, v99, v114, v91
    v_cvt_pk_bf16_f32 v81, v90, -v91
    s_waitcnt lgkmcnt(8)
    v_mul_f32 v88, v100, v116
    v_mul_f32 v89, v100, v117
    v_fma_f32 v88, -v101, v117, v88
    v_fma_f32 v89, v101, v116, v89
    v_cvt_pk_bf16_f32 v82, v88, -v89
    v_mul_f32 v90, v102, v118
    v_mul_f32 v91, v102, v119
    v_fma_f32 v90, -v103, v119, v90
    v_fma_f32 v91, v103, v118, v91
    v_cvt_pk_bf16_f32 v83, v90, -v91
    ds_write_b128 v11, v[80:83] offset:0
    s_waitcnt lgkmcnt(5)
    v_mul_f32 v88, v104, v120
    v_mul_f32 v89, v104, v121
    v_fma_f32 v88, -v105, v121, v88
    v_fma_f32 v89, v105, v120, v89
    v_cvt_pk_bf16_f32 v84, v88, -v89
    v_mul_f32 v90, v106, v122
    v_mul_f32 v91, v106, v123
    v_fma_f32 v90, -v107, v123, v90
    v_fma_f32 v91, v107, v122, v91
    v_cvt_pk_bf16_f32 v85, v90, -v91
    s_waitcnt lgkmcnt(1)
    v_mul_f32 v88, v108, v124
    v_mul_f32 v89, v108, v125
    v_fma_f32 v88, -v109, v125, v88
    v_fma_f32 v89, v109, v124, v89
    v_cvt_pk_bf16_f32 v86, v88, -v89
    v_mul_f32 v90, v110, v126
    v_mul_f32 v91, v110, v127
    v_fma_f32 v90, -v111, v127, v90
    v_fma_f32 v91, v111, v126, v91
    v_cvt_pk_bf16_f32 v87, v90, -v91
    ds_write_b128 v11, v[84:87] offset:1024
    s_waitcnt lgkmcnt(0)
    s_barrier
    ds_read_b128 v[80:83], v3 offset:0
    ds_read_b128 v[84:87], v3 offset:1024
    ds_read_b128 v[88:91], v3 offset:2048
    ds_read_b128 v[92:95], v3 offset:3072
    ds_read_b128 v[112:115], v3 offset:4096
    ds_read_b128 v[116:119], v3 offset:5120
    ds_read_b128 v[120:123], v3 offset:6144
    ds_read_b128 v[124:127], v3 offset:7168
    s_waitcnt lgkmcnt(7)
    v_mfma_f32_32x32x16_bf16 v[96:111], v[152:155], v[80:83], 0
    s_waitcnt lgkmcnt(6)
    v_mfma_f32_32x32x16_bf16 v[96:111], v[156:159], v[84:87], v[96:111]
    s_waitcnt lgkmcnt(5)
    v_mfma_f32_32x32x16_bf16 v[96:111], v[160:163], v[88:91], v[96:111]
    s_waitcnt lgkmcnt(4)
    v_mfma_f32_32x32x16_bf16 v[96:111], v[164:167], v[92:95], v[96:111]
    s_waitcnt lgkmcnt(3)
    v_mfma_f32_32x32x16_bf16 v[96:111], v[128:131], v[112:115], v[96:111]
    s_waitcnt lgkmcnt(2)
    v_mfma_f32_32x32x16_bf16 v[96:111], v[132:135], v[116:119], v[96:111]
    s_waitcnt lgkmcnt(1)
    v_mfma_f32_32x32x16_bf16 v[96:111], v[136:139], v[120:123], v[96:111]
    s_waitcnt lgkmcnt(0)
    v_mfma_f32_32x32x16_bf16 v[96:111], v[140:143], v[124:127], v[96:111]
    s_mov_b32 exec_lo, 2147450879
    s_mov_b32 exec_hi, 2147450879
    s_nop 9
    v_cvt_pk_bf16_f32 v144, v96, v97
    v_cvt_pk_bf16_f32 v145, v98, v99
    v_cvt_pk_bf16_f32 v146, v100, v101
    v_cvt_pk_bf16_f32 v147, v102, v103
    v_cvt_pk_bf16_f32 v148, v104, v105
    v_cvt_pk_bf16_f32 v149, v106, v107
    v_cvt_pk_bf16_f32 v150, v108, v109
    v_cvt_pk_bf16_f32 v151, v110, v111
    s_mov_b64 exec, -1
    buffer_store_dword v144, v2, s[8:11], s55 offen offset:0 sc1
    buffer_store_dword v145, v2, s[8:11], s55 offen offset:256 sc1
    buffer_store_dword v146, v2, s[8:11], s55 offen offset:512 sc1
    buffer_store_dword v147, v2, s[8:11], s55 offen offset:768 sc1
    buffer_store_dword v148, v2, s[8:11], s55 offen offset:1024 sc1
    buffer_store_dword v149, v2, s[8:11], s55 offen offset:1280 sc1
    buffer_store_dword v150, v2, s[8:11], s55 offen offset:1536 sc1
    buffer_store_dword v151, v2, s[8:11], s55 offen offset:1792 sc1
    s_setprio 3
    s_mov_b32 s59, 34304
    v_lshl_add_u32 v12, v4, 2, s59
    ds_read2_b32 v[136:137], v12 offset0:0 offset1:64
    ds_read2_b32 v[138:139], v12 offset0:128 offset1:192
    v_cvt_f32_u32 v9, v4
    v_fmamk_f32 v9, v9, 0x3d000000, v15
    s_lshl_b32 s55, s48, 3
    v_add_u32 v10, s55, v14
    v_cvt_f32_u32 v10, v10
    v_mul_f32 v10, v10, v9
    v_cos_f32 v112, v10
    v_sin_f32 v113, v10
    v_fma_f32 v10, v9, 2.0, v10
    v_cos_f32 v114, v10
    v_sin_f32 v115, v10
    v_fma_f32 v10, v9, 2.0, v10
    v_cos_f32 v116, v10
    v_sin_f32 v117, v10
    v_fma_f32 v10, v9, 2.0, v10
    v_cos_f32 v118, v10
    v_sin_f32 v119, v10
    v_cvt_pk_bf16_f32 v128, v112, v113
    v_cvt_pk_bf16_f32 v132, -v113, v112
    v_cvt_pk_bf16_f32 v129, v114, v115
    v_cvt_pk_bf16_f32 v133, -v115, v114
    v_cvt_pk_bf16_f32 v130, v116, v117
    v_cvt_pk_bf16_f32 v134, -v117, v116
    v_cvt_pk_bf16_f32 v131, v118, v119
    v_cvt_pk_bf16_f32 v135, -v119, v118
    v_lshlrev_b32 v8, 4, v0
    ds_write_b128 v8, v[128:131] offset:43520
    ds_write_b128 v8, v[132:135] offset:47616
    s_mov_b32 s54, s3
    s_lshl_b32 s55, s49, 7
    s_mul_i32 s56, s48, 16640
    s_add_u32 s24, s55, s56
    s_add_u32 s25, s24, 531456
    s_add_u32 s26, s24, 1062912
    s_add_u32 s27, s24, 1594368
    s_add_u32 s28, s24, 8320
    s_add_u32 s29, s25, 8320
    s_add_u32 s30, s26, 8320
    s_add_u32 s31, s27, 8320
    s_lshl_b32 s56, s48, 13
    s_add_u32 s55, s56, 4096
    v_lshrrev_b32 v0, 3, v1
    v_mul_u32_u24 v0, 66560, v0
    v_and_b32 v10, 112, v3
    v_add_u32 v0, v0, v10
    s_waitcnt lgkmcnt(0)
    s_barrier
    v_add_f32 v136, v136, v138
    v_add_f32 v137, v137, v139
    v_add_f32 v136, v136, v137
    v_cvt_pk_bf16_f32 v136, 0, v136
    v_mul_f32 v136, 0xbfb8aa3b, v136
    v_exp_f32 v136, v136
    s_nop 0
    v_add_f32 v136, 1.0, v136
    v_rcp_f32 v136, v136
    s_add_u32 s62, s62, 2
    s_add_u32 s63, s63, 2
    v_cvt_pk_bf16_f32 v136, 0, v136
    v_sub_f32 v137, 1.0, v136
    v_cvt_pk_bf16_f32 v137, 0, v137
    v_mul_f32 v136, 0x36124925, v136
    ds_write2_b32 v12, v136, v137 offset0:0 offset1:32
    s_lshr_b32 s16, s49, 4
    s_lshr_b32 s17, s49, 3
    s_xor_b32 s17, s17, s16
    s_and_b32 s17, s17, 1
    s_and_b32 s16, s16, 1
    s_lshl_b32 s16, s16, 1
    s_or_b32 s16, s16, s17
    s_lshl_b32 s16, s16, 2
    s_bfe_u32 s17, s49, 0x20001
    s_or_b32 s16, s16, s17
    s_and_b32 s17, s49, 32
    s_or_b32 s16, s16, s17
    s_and_b32 s17, s49, 1
    s_lshl_b32 s17, s17, 4
    s_or_b32 s16, s16, s17
    s_lshl_b32 s16, s16, 3
    s_lshl_b32 s17, s51, 13
    s_add_u32 s16, s16, s17
    s_add_u32 s16, s16, 4390912
    s_mul_i32 s17, s51, 67584
    s_lshl_b32 s18, s49, 6
    s_add_u32 s17, s17, s18
    s_add_u32 s17, s17, 2228224
    s_add_u32 s18, s17, 945152
    s_mov_b32 s12, s42
    s_mov_b32 s13, s43
    s_mov_b32 s14, 1835008
    s_lshl_b32 s19, s51, 5
    s_mul_i32 s20, s49, 896
    s_add_u32 s19, s19, s20
    s_lshl_b32 s20, s57, 31
    s_lshl_b32 s21, s57, 11
    ds_read_b128 v[80:83], v3 offset:43520
    ds_read_b128 v[84:87], v3 offset:44544
    ds_read_b128 v[88:91], v3 offset:45568
    ds_read_b128 v[92:95], v3 offset:46592
    ds_read_b128 v[96:99], v3 offset:47616
    ds_read_b128 v[100:103], v3 offset:48640
    ds_read_b128 v[104:107], v3 offset:49664
    ds_read_b128 v[108:111], v3 offset:50688
    s_waitcnt vmcnt(0)
    s_mov_b32 m0, s56
    s_nop 0
    buffer_load_dwordx4 v0, s[8:11], s24 offen offset:0 sc1 lds
    buffer_load_dwordx4 v0, s[8:11], s25 offen offset:1024 sc1 lds
    buffer_load_dwordx4 v0, s[8:11], s26 offen offset:2048 sc1 lds
    buffer_load_dwordx4 v0, s[8:11], s27 offen offset:3072 sc1 lds
    s_mov_b32 m0, s55
    s_nop 0
    buffer_load_dwordx4 v0, s[8:11], s28 offen offset:0 sc1 lds
    buffer_load_dwordx4 v0, s[8:11], s29 offen offset:1024 sc1 lds
    buffer_load_dwordx4 v0, s[8:11], s30 offen offset:2048 sc1 lds
    buffer_load_dwordx4 v0, s[8:11], s31 offen offset:3072 sc1 lds
    s_setprio 0
    v_add_u32 v2, s56, v2
    s_add_u32 s59, s56, 60
    v_lshl_add_u32 v4, v1, 6, s59
    v_add_u32 v5, s56, v3
    s_mov_b32 s59, 0
    s_setprio 3
    v_or_b32 v4, 60, v5
L_VP:
    s_waitcnt vmcnt(0)
    ds_read2st64_b32 v[112:113], v4 offset0:0 offset1:4
    ds_read2st64_b32 v[114:115], v4 offset0:8 offset1:12
    ds_read2st64_b32 v[116:117], v4 offset0:16 offset1:20
    ds_read2st64_b32 v[118:119], v4 offset0:24 offset1:28
    v_mov_b32 v6, s54
    s_add_u32 s59, s59, 1
    s_waitcnt lgkmcnt(0)
    v_xor_b32 v7, v6, v112
    v_bitop3_b32 v7, v7, v113, v6 bitop3:0xf6
    v_bitop3_b32 v7, v7, v114, v6 bitop3:0xf6
    v_bitop3_b32 v7, v7, v115, v6 bitop3:0xf6
    v_bitop3_b32 v7, v7, v116, v6 bitop3:0xf6
    v_bitop3_b32 v7, v7, v117, v6 bitop3:0xf6
    v_bitop3_b32 v7, v7, v118, v6 bitop3:0xf6
    v_bitop3_b32 v7, v7, v119, v6 bitop3:0xf6
    v_cmp_ne_u32 vcc, 0, v7
    s_cbranch_vccz L_VD
    s_cmp_gt_u32 s59, 4000
    s_cbranch_scc1 L_VD
    s_sleep 2
    s_mov_b32 m0, s56
    v_cmp_ne_u32 vcc, s54, v112
    s_nop 0
    s_mov_b64 exec, vcc
    s_cbranch_execz L_VP0
    buffer_load_dwordx4 v0, s[8:11], s24 offen offset:0 sc1 lds
L_VP0:
    s_mov_b64 exec, -1
    v_cmp_ne_u32 vcc, s54, v113
    s_nop 0
    s_mov_b64 exec, vcc
    s_cbranch_execz L_VP1
    buffer_load_dwordx4 v0, s[8:11], s25 offen offset:1024 sc1 lds
L_VP1:
    s_mov_b64 exec, -1
    v_cmp_ne_u32 vcc, s54, v114
    s_nop 0
    s_mov_b64 exec, vcc
    s_cbranch_execz L_VP2
    buffer_load_dwordx4 v0, s[8:11], s26 offen offset:2048 sc1 lds
L_VP2:
    s_mov_b64 exec, -1
    v_cmp_ne_u32 vcc, s54, v115
    s_nop 0
    s_mov_b64 exec, vcc
    s_cbranch_execz L_VP3
    buffer_load_dwordx4 v0, s[8:11], s27 offen offset:3072 sc1 lds
L_VP3:
    s_mov_b64 exec, -1
    s_mov_b32 m0, s55
    v_cmp_ne_u32 vcc, s54, v116
    s_nop 0
    s_mov_b64 exec, vcc
    s_cbranch_execz L_VP4
    buffer_load_dwordx4 v0, s[8:11], s28 offen offset:0 sc1 lds
L_VP4:
    s_mov_b64 exec, -1
    v_cmp_ne_u32 vcc, s54, v117
    s_nop 0
    s_mov_b64 exec, vcc
    s_cbranch_execz L_VP5
    buffer_load_dwordx4 v0, s[8:11], s29 offen offset:1024 sc1 lds
L_VP5:
    s_mov_b64 exec, -1
    v_cmp_ne_u32 vcc, s54, v118
    s_nop 0
    s_mov_b64 exec, vcc
    s_cbranch_execz L_VP6
    buffer_load_dwordx4 v0, s[8:11], s30 offen offset:2048 sc1 lds
L_VP6:
    s_mov_b64 exec, -1
    v_cmp_ne_u32 vcc, s54, v119
    s_nop 0
    s_mov_b64 exec, vcc
    s_cbranch_execz L_VP7
    buffer_load_dwordx4 v0, s[8:11], s31 offen offset:3072 sc1 lds
L_VP7:
    s_mov_b64 exec, -1
    s_branch L_VP
L_VD:
    s_setprio 0
    ds_read2st64_b32 v[112:113], v2 offset0:0 offset1:1
    ds_read2st64_b32 v[114:115], v2 offset0:2 offset1:3
    ds_read2st64_b32 v[116:117], v2 offset0:4 offset1:5
    ds_read2st64_b32 v[118:119], v2 offset0:6 offset1:7
    ds_read2st64_b32 v[120:121], v2 offset0:8 offset1:9
    ds_read2st64_b32 v[122:123], v2 offset0:10 offset1:11
    ds_read2st64_b32 v[124:125], v2 offset0:12 offset1:13
    ds_read2st64_b32 v[126:127], v2 offset0:14 offset1:15
    ds_read2st64_b32 v[160:161], v2 offset0:16 offset1:17
    ds_read2st64_b32 v[162:163], v2 offset0:18 offset1:19
    ds_read2st64_b32 v[164:165], v2 offset0:20 offset1:21
    ds_read2st64_b32 v[166:167], v2 offset0:22 offset1:23
    ds_read2st64_b32 v[8:9], v2 offset0:24 offset1:25
    ds_read2st64_b32 v[10:11], v2 offset0:26 offset1:27
    s_waitcnt lgkmcnt(12)
    v_mfma_f32_32x32x16_bf16 v[128:143], v[112:115], v[80:83], 0
    s_waitcnt lgkmcnt(10)
    v_mfma_f32_32x32x16_bf16 v[128:143], v[116:119], v[84:87], v[128:143]
    s_waitcnt lgkmcnt(8)
    v_mfma_f32_32x32x16_bf16 v[128:143], v[120:123], v[88:91], v[128:143]
    s_waitcnt lgkmcnt(6)
    v_mfma_f32_32x32x16_bf16 v[128:143], v[124:127], v[92:95], v[128:143]
    ds_read2st64_b32 v[12:13], v2 offset0:28 offset1:29
    ds_read2st64_b32 v[14:15], v2 offset0:30 offset1:31
    s_waitcnt lgkmcnt(6)
    v_mfma_f32_32x32x16_bf16 v[144:159], v[160:163], v[80:83], 0
    v_lshrrev_b32 v0, 2, v1
    v_mul_u32_u24 v0, 4224, v0
    v_and_b32 v2, 48, v3
    v_add_u32 v0, v0, v2
    s_waitcnt lgkmcnt(4)
    v_mfma_f32_32x32x16_bf16 v[144:159], v[164:167], v[84:87], v[144:159]
    v_lshrrev_b32 v7, 5, v1
    v_add_u32 v4, s21, v3
    s_waitcnt lgkmcnt(2)
    v_mfma_f32_32x32x16_bf16 v[144:159], v[8:11], v[88:91], v[144:159]
    v_cvt_pk_bf16_f32 v128, v128, v129
    v_cvt_pk_bf16_f32 v129, v130, v131
    v_cvt_pk_bf16_f32 v130, v132, v133
    v_cvt_pk_bf16_f32 v131, v134, v135
    s_waitcnt lgkmcnt(0)
    v_mfma_f32_32x32x16_bf16 v[144:159], v[12:15], v[92:95], v[144:159]
    v_cvt_pk_bf16_f32 v136, v136, v137
    v_cvt_pk_bf16_f32 v137, v138, v139
    v_cvt_pk_bf16_f32 v138, v140, v141
    v_cvt_pk_bf16_f32 v139, v142, v143
    v_mfma_f32_32x32x16_bf16 v[80:95], v[112:115], v[96:99], 0
    ds_write_b128 v5, v[128:131] offset:0
    v_mfma_f32_32x32x16_bf16 v[80:95], v[116:119], v[100:103], v[80:95]
    ds_write_b128 v5, v[136:139] offset:2048
    v_mfma_f32_32x32x16_bf16 v[80:95], v[120:123], v[104:107], v[80:95]
    s_nop 2
    v_cvt_pk_bf16_f32 v144, v144, v145
    v_cvt_pk_bf16_f32 v145, v146, v147
    v_cvt_pk_bf16_f32 v146, v148, v149
    v_cvt_pk_bf16_f32 v147, v150, v151
    v_mfma_f32_32x32x16_bf16 v[80:95], v[124:127], v[108:111], v[80:95]
    v_cvt_pk_bf16_f32 v152, v152, v153
    v_cvt_pk_bf16_f32 v153, v154, v155
    v_cvt_pk_bf16_f32 v154, v156, v157
    v_cvt_pk_bf16_f32 v155, v158, v159
    v_mfma_f32_32x32x16_bf16 v[112:127], v[160:163], v[96:99], 0
    ds_write_b128 v5, v[144:147] offset:4096
    v_mfma_f32_32x32x16_bf16 v[112:127], v[164:167], v[100:103], v[112:127]
    ds_write_b128 v5, v[152:155] offset:6144
    v_mfma_f32_32x32x16_bf16 v[112:127], v[8:11], v[104:107], v[112:127]
    s_nop 2
    v_cvt_pk_bf16_f32 v80, v80, v81
    v_cvt_pk_bf16_f32 v81, v82, v83
    v_cvt_pk_bf16_f32 v82, v84, v85
    v_cvt_pk_bf16_f32 v83, v86, v87
    v_mfma_f32_32x32x16_bf16 v[112:127], v[12:15], v[108:111], v[112:127]
    v_cvt_pk_bf16_f32 v88, v88, v89
    v_cvt_pk_bf16_f32 v89, v90, v91
    v_cvt_pk_bf16_f32 v90, v92, v93
    v_cvt_pk_bf16_f32 v91, v94, v95
    ds_write_b128 v5, v[80:83] offset:1024
    ds_write_b128 v5, v[88:91] offset:3072
    s_add_u32 m0, s61, 43520
    v_and_b32 v6, 31, v1
    s_mov_b32 s59, 34304
    v_lshl_add_u32 v2, v6, 2, s59
    s_nop 1
    v_cvt_pk_bf16_f32 v112, v112, v113
    v_cvt_pk_bf16_f32 v113, v114, v115
    v_cvt_pk_bf16_f32 v114, v116, v117
    v_cvt_pk_bf16_f32 v115, v118, v119
    ds_write_b128 v5, v[112:115] offset:5120
    v_cvt_pk_bf16_f32 v120, v120, v121
    v_cvt_pk_bf16_f32 v121, v122, v123
    v_cvt_pk_bf16_f32 v122, v124, v125
    v_cvt_pk_bf16_f32 v123, v126, v127
    ds_write_b128 v5, v[120:123] offset:7168
    s_waitcnt lgkmcnt(0)
    s_barrier
    s_cmp_ge_u32 s58, 7
    s_cbranch_scc1 L_AIDLE
    ds_read_b128 v[96:99], v4 offset:0
    ds_read_b128 v[100:103], v4 offset:1024
    ds_read_b128 v[104:107], v4 offset:4096
    ds_read_b128 v[108:111], v4 offset:5120
    ds_read_b128 v[112:115], v4 offset:8192
    ds_read_b128 v[116:119], v4 offset:9216
    ds_read_b128 v[120:123], v4 offset:12288
    ds_read_b128 v[124:127], v4 offset:13312
    ds_read2_b32 v[8:9], v2 offset0:0 offset1:32
    s_waitcnt lgkmcnt(8)
    v_mfma_f32_32x32x16_bf16 v[144:159], v[16:19], v[96:99], 0
    ds_read_b128 v[96:99], v4 offset:16384
    v_and_b32 v91, 15, v1
    v_bfe_u32 v92, v1, 4, 1
    s_waitcnt lgkmcnt(8)
    v_mfma_f32_32x32x16_bf16 v[144:159], v[20:23], v[100:103], v[144:159]
    ds_read_b128 v[100:103], v4 offset:17408
    v_mul_u32_u24 v92, 224, v92
    v_add_lshl_u32 v91, v91, v92, 9
    s_waitcnt lgkmcnt(8)
    v_mfma_f32_32x32x16_bf16 v[144:159], v[24:27], v[104:107], v[144:159]
    ds_read_b128 v[104:107], v4 offset:20480
    v_add_u32 v13, s61, v3
    v_xor_b32 v14, 0x800, v13
    s_waitcnt lgkmcnt(8)
    v_mfma_f32_32x32x16_bf16 v[144:159], v[28:31], v[108:111], v[144:159]
    ds_read_b128 v[108:111], v4 offset:21504
    v_mul_u32_u24 v15, 57344, v6
    v_lshl_add_u32 v15, v7, 4, v15
    s_waitcnt lgkmcnt(8)
    v_mfma_f32_32x32x16_bf16 v[144:159], v[32:35], v[112:115], v[144:159]
    ds_read_b128 v[112:115], v4 offset:24576
    s_waitcnt lgkmcnt(8)
    v_mfma_f32_32x32x16_bf16 v[144:159], v[36:39], v[116:119], v[144:159]
    ds_read_b128 v[116:119], v4 offset:25600
    s_waitcnt lgkmcnt(8)
    v_mfma_f32_32x32x16_bf16 v[144:159], v[40:43], v[120:123], v[144:159]
    ds_read_b128 v[120:123], v4 offset:28672
    s_waitcnt lgkmcnt(8)
    v_mfma_f32_32x32x16_bf16 v[144:159], v[44:47], v[124:127], v[144:159]
    ds_read_b128 v[124:127], v4 offset:29696
    s_waitcnt lgkmcnt(7)
    v_mfma_f32_32x32x16_bf16 v[144:159], v[48:51], v[96:99], v[144:159]
    v_xor_b32 v10, s20, v8
    s_mov_b32 s59, 0
    v_mov_b32 v94, s62
    s_waitcnt lgkmcnt(6)
    v_mfma_f32_32x32x16_bf16 v[144:159], v[52:55], v[100:103], v[144:159]
    s_mov_b32 exec_lo, 0xffff0000
    s_mov_b32 exec_hi, 0xffff0000
    v_mov_b32 v94, s63
    s_mov_b64 exec, -1
    s_waitcnt lgkmcnt(5)
    v_mfma_f32_32x32x16_bf16 v[144:159], v[56:59], v[104:107], v[144:159]
    v_lshl_add_u32 v92, v6, 6, s61
    v_and_b32 v93, 3, v1
    v_bfe_u32 v95, v1, 2, 3
    s_waitcnt lgkmcnt(4)
    v_mfma_f32_32x32x16_bf16 v[144:159], v[60:63], v[108:111], v[144:159]
    v_lshl_add_u32 v93, v93, 3, v95
    v_lshl_add_u32 v93, v93, 1, s61
    v_lshl_add_u32 v93, v7, 9, v93
    s_waitcnt lgkmcnt(3)
    v_mfma_f32_32x32x16_bf16 v[144:159], v[64:67], v[112:115], v[144:159]
    buffer_load_dwordx4 v0, s[8:11], s17 offen sc1 lds
    buffer_load_dwordx4 v0, s[8:11], s18 offen offset:1024 sc1 lds
    buffer_load_dwordx2 v[88:89], v91, s[8:11], s16 offen sc1
    s_waitcnt lgkmcnt(2)
    v_mfma_f32_32x32x16_bf16 v[144:159], v[68:71], v[116:119], v[144:159]
    s_waitcnt lgkmcnt(1)
    v_mfma_f32_32x32x16_bf16 v[144:159], v[72:75], v[120:123], v[144:159]
    s_waitcnt lgkmcnt(0)
    v_mfma_f32_32x32x16_bf16 v[144:159], v[76:79], v[124:127], v[144:159]
    s_nop 11
    ds_write_b128 v13, v[152:155] offset:35328
    ds_write_b128 v13, v[156:159] offset:36352
    v_mul_f32 v96, v8, v144
    v_mul_f32 v104, v10, v144
    v_mul_f32 v97, v8, v145
    v_mul_f32 v105, v10, v145
    v_mul_f32 v98, v8, v146
    v_mul_f32 v106, v10, v146
    v_mul_f32 v99, v8, v147
    v_mul_f32 v107, v10, v147
    v_mul_f32 v100, v8, v148
    v_mul_f32 v108, v10, v148
    v_mul_f32 v101, v8, v149
    v_mul_f32 v109, v10, v149
    v_mul_f32 v102, v8, v150
    v_mul_f32 v110, v10, v150
    v_mul_f32 v103, v8, v151
    v_mul_f32 v111, v10, v151
    s_waitcnt lgkmcnt(0)
    s_barrier
    ds_read_b128 v[80:83], v14 offset:35328
    ds_read_b128 v[84:87], v14 offset:36352
    s_waitcnt lgkmcnt(0)
    v_fmac_f32 v96, v8, v80
    v_fma_f32 v104, -v10, v80, v104
    v_fmac_f32 v97, v8, v81
    v_fma_f32 v105, -v10, v81, v105
    v_fmac_f32 v98, v8, v82
    v_fma_f32 v106, -v10, v82, v106
    v_fmac_f32 v99, v8, v83
    v_fma_f32 v107, -v10, v83, v107
    v_fmac_f32 v100, v8, v84
    v_fma_f32 v108, -v10, v84, v108
    v_fmac_f32 v101, v8, v85
    v_fma_f32 v109, -v10, v85, v109
    v_fmac_f32 v102, v8, v86
    v_fma_f32 v110, -v10, v86, v110
    v_fmac_f32 v103, v8, v87
    v_fma_f32 v111, -v10, v87, v111
L_BP:
    s_waitcnt vmcnt(0)
    ds_read_b32 v90, v92 offset:43580
    ds_write_b32 v92, v88 offset:43580
    ds_read_u16_d16_hi v128, v93 offset:43520
    ds_read_u16_d16_hi v129, v93 offset:43584
    ds_read_u16_d16_hi v130, v93 offset:43648
    ds_read_u16_d16_hi v131, v93 offset:43712
    ds_read_u16_d16_hi v132, v93 offset:43776
    ds_read_u16_d16_hi v133, v93 offset:43840
    ds_read_u16_d16_hi v134, v93 offset:43904
    ds_read_u16_d16_hi v135, v93 offset:43968
    ds_read_u16_d16_hi v136, v93 offset:44544
    ds_read_u16_d16_hi v137, v93 offset:44608
    ds_read_u16_d16_hi v138, v93 offset:44672
    ds_read_u16_d16_hi v139, v93 offset:44736
    ds_read_u16_d16_hi v140, v93 offset:44800
    ds_read_u16_d16_hi v141, v93 offset:44864
    ds_read_u16_d16_hi v142, v93 offset:44928
    ds_read_u16_d16_hi v143, v93 offset:44992
    v_cmp_ne_u32 s[46:47], v94, v89
    s_waitcnt lgkmcnt(14)
    v_cmp_ne_u32 vcc, v94, v90
    s_nop 0
    s_or_b64 vcc, vcc, s[46:47]
    s_cbranch_vccz L_BD
    s_add_u32 s59, s59, 1
    s_cmp_gt_u32 s59, 4000
    s_cbranch_scc1 L_BD
    s_sleep 1
    s_waitcnt lgkmcnt(0)
    buffer_load_dwordx4 v0, s[8:11], s17 offen sc1 lds
    buffer_load_dwordx4 v0, s[8:11], s18 offen offset:1024 sc1 lds
    buffer_load_dwordx2 v[88:89], v91, s[8:11], s16 offen sc1
    s_branch L_BP
L_BD:
    s_waitcnt lgkmcnt(8)
    v_fmac_f32 v96, v9, v128
    v_fmac_f32 v97, v9, v129
    v_cvt_pk_bf16_f32 v160, v96, v97
    v_fmac_f32 v98, v9, v130
    v_fmac_f32 v99, v9, v131
    v_cvt_pk_bf16_f32 v161, v98, v99
    v_fmac_f32 v100, v9, v132
    v_fmac_f32 v101, v9, v133
    v_cvt_pk_bf16_f32 v162, v100, v101
    v_fmac_f32 v102, v9, v134
    v_fmac_f32 v103, v9, v135
    v_cvt_pk_bf16_f32 v163, v102, v103
    buffer_store_dwordx4 v[160:163], v15, s[12:15], s19 offen offset:0
    s_waitcnt lgkmcnt(0)
    v_fmac_f32 v104, v9, v136
    v_fmac_f32 v105, v9, v137
    v_cvt_pk_bf16_f32 v164, v104, v105
    v_fmac_f32 v106, v9, v138
    v_fmac_f32 v107, v9, v139
    v_cvt_pk_bf16_f32 v165, v106, v107
    v_fmac_f32 v108, v9, v140
    v_fmac_f32 v109, v9, v141
    v_cvt_pk_bf16_f32 v166, v108, v109
    v_fmac_f32 v110, v9, v142
    v_fmac_f32 v111, v9, v143
    v_cvt_pk_bf16_f32 v167, v110, v111
    buffer_store_dwordx4 v[164:167], v15, s[12:15], s19 offen offset:448
    s_or_b32 s28, s49, s57
    s_cmp_lg_u32 s28, 0
    s_cbranch_scc1 L_AEND
    s_lshl_b32 s28, s58, 2
    v_mov_b32 v4, s62
    v_mov_b32 v6, s63
    v_mov_b32 v5, 2162688
    s_mov_b64 exec, 1
    buffer_store_dword v4, v5, s[8:11], s28 offen
    buffer_store_dword v6, v5, s[8:11], s28 offen offset:28
    s_branch L_AEND
L_AIDLE:
    s_barrier
    s_cmp_lg_u32 s2, 63
    s_cbranch_scc1 L_AEND
    v_mov_b32 v4, s54
    v_mov_b32 v5, 2162744
    s_mov_b64 exec, 1
    buffer_store_dword v4, v5, s[8:11], 0 offen
L_AEND:
    s_endpgm
L_B:
    s_mov_b32 s10, 4718592
    s_mov_b32 s11, 0x20000
    s_setprio 3
    s_lshr_b32 s58, s49, 5
    s_and_b32 s59, s49, 31
    v_bfe_u32 v18, v1, 2, 2
    v_lshrrev_b32 v17, 4, v1
    v_and_b32 v22, 3, v1
    v_and_b32 v19, 7, v1
    v_lshrrev_b32 v20, 3, v1
    v_lshl_add_u32 v134, v19, 6, v20
    v_mul_u32_u24 v134, 896, v134
    s_lshr_b32 s60, s59, 3
    s_and_b32 s61, s59, 7
    s_lshl_b32 s63, s61, 2
    s_add_u32 s63, s63, s60
    s_lshl_b32 s63, s63, 7
    s_lshl_b32 s60, s60, 6
    s_add_u32 s60, s60, s61
    s_mul_i32 s60, s60, 7168
    s_lshl_b32 s62, s58, 2
    s_add_u32 s62, s62, s48
    s_lshl_b32 s61, s62, 4
    s_add_u32 s0, s60, s61
    s_mul_i32 s51, s48, 5632
    s_add_u32 s51, s51, 12288
    s_add_u32 m0, s51, 4608
    s_lshl_b32 s61, s58, 2
    s_add_u32 s1, s61, 2162688
    s_and_b32 s50, s50, -4
    v_lshl_add_u32 v39, v19, 4, s51
    v_lshl_add_u32 v39, v20, 1, v39
    v_mul_u32_u24 v135, 4224, v20
    v_lshl_add_u32 v135, v19, 4, v135
    v_lshlrev_b32 v9, 1, v1
    v_and_b32 v9, 0x78, v9
    s_mul_i32 s52, s62, 33792
    s_add_u32 s52, s52, s63
    s_add_u32 s52, s52, 2228224
    s_lshl_b32 s60, s62, 5
    s_add_u32 s60, s60, s59
    s_lshl_b32 s60, s60, 7
    s_add_u32 s60, s60, 4128768
    v_lshlrev_b32 v132, 9, v20
    v_lshl_add_u32 v132, v19, 4, v132
    v_lshlrev_b32 v140, 7, v19
    v_lshl_add_u32 v141, v20, 4, v140
    v_add_u32 v141, s51, v141
    v_and_b32 v20, 4, v20
    v_lshl_add_u32 v140, v20, 1, v140
    s_lshr_b32 s14, s49, 3
    s_lshl_b32 s14, s14, 2
    s_add_u32 s14, s14, s48
    s_lshl_b32 s14, s14, 10
    s_and_b32 s15, s49, 7
    s_lshl_b32 s15, s15, 4
    s_add_u32 s14, s14, s15
    s_add_u32 s14, s14, 4128768
    s_setprio 3
    v_mov_b32 v136, 0
    v_mov_b32 v137, 0
    v_mov_b32 v138, 0
    v_mov_b32 v139, 0
    v_lshlrev_b32 v131, 4, v0
    s_cmp_lg_u32 s48, 0
    s_cbranch_scc1 L_B1
    s_mov_b64 exec, 0x1ffffff
    ds_write_b128 v3, v[136:139] offset:35712
    ds_write_b128 v3, v[136:139] offset:40224
    ds_write_b128 v3, v[136:139] offset:44736
    ds_write_b128 v3, v[136:139] offset:49248
    s_mov_b64 exec, -1
L_B1:
    v_and_b32 v19, 15, v1
    v_mul_u32_u24 v37, 288, v19
    v_lshl_add_u32 v37, v17, 4, v37
    v_add_u32 v37, s51, v37
    s_mul_i32 s56, s48, 3072
    v_lshl_add_u32 v129, v19, 4, s56
    v_lshl_add_u32 v129, v17, 9, v129
    v_mul_u32_u24 v23, 4512, v18
    s_mul_i32 s53, s49, 4224
    s_add_u32 s53, s53, 2228224
    s_lshl_b32 s15, s48, 7
    s_add_u32 s15, s15, s53
    v_lshlrev_b32 v19, 2, v0
    v_sub_u32 v128, 2556, v19
    v_add_u32 v130, 4, v128
    s_cmp_lt_u32 s48, 2
    s_cbranch_scc1 L_B2
    v_and_b32 v19, 0x1f0, v3
    v_sub_u32 v142, 496, v19
    v_lshrrev_b32 v20, 5, v1
    s_cmp_eq_u32 s48, 2
    s_movk_i32 s56, 1024
    s_cmovk_i32 s56, 1544
    s_cselect_b32 s57, 8, 1024
    v_mul_u32_u24 v20, s57, v20
    v_sub_u32 v20, s56, v20
    v_add_u32 v128, v20, v142
    v_add_u32 v130, 16, v128
    s_movk_i32 s57, 1536
    s_cmovk_i32 s57, 2048
    s_mov_b64 exec, 1
    v_mov_b32 v130, s57
    s_mov_b32 exec_hi, 1
    s_mov_b32 exec_lo, 0
    v_mov_b32 v130, s56
    s_mov_b64 exec, -1
L_B2:
    v_add_u32 v127, 36096, v131
    v_lshrrev_b32 v19, 1, v18
    v_xor_b32 v20, v18, v19
    v_xor_b32 v21, s48, v22
    v_and_b32 v38, 1, v21
    v_lshrrev_b32 v21, 1, v21
    v_lshl_add_u32 v21, v21, 2, v20
    v_sub_u32 v21, v17, v21
    v_lshlrev_b32 v21, 4, v21
    v_mul_u32_u24 v38, 4208, v38
    s_lshl_b32 s56, s48, 7
    s_sub_u32 s57, 27792, s56
    v_add3_u32 v120, v21, v38, s57
    v_lshl_add_u32 v21, v22, 7, v23
    v_lshl_add_u32 v21, v17, 4, v21
    s_sub_u32 s57, 36096, s56
    v_add_u32 v121, s57, v21
    v_lshrrev_b32 v21, 5, v1
    v_xor_b32 v21, v17, v21
    v_lshl_add_u32 v21, v21, 2, v18
    v_lshlrev_b32 v21, 7, v21
    v_lshl_add_u32 v122, v22, 4, v21
    s_mul_i32 s57, s48, 6144
    v_lshl_add_u32 v126, v1, 2, s57
    s_xor_b32 s57, s48, 1
    s_mul_i32 s57, s57, 6144
    v_lshl_add_u32 v123, v1, 2, s57
    s_xor_b32 s57, s48, 2
    s_mul_i32 s57, s57, 6144
    v_lshl_add_u32 v124, v1, 2, s57
    s_xor_b32 s57, s48, 3
    s_mul_i32 s57, s57, 6144
    v_lshl_add_u32 v125, v1, 2, s57
    s_lshr_b32 s56, s48, 1
    s_lshl_b32 s56, s56, 5
    s_and_b32 s57, s48, 1
    s_add_u32 s56, s56, s57
    s_lshl_b32 s56, s56, 6
    s_add_u32 s56, s56, s53
    s_setprio 3
    global_load_short_d16_hi v4, v143, s[28:29] nt
    global_load_short_d16_hi v5, v143, s[30:31] nt
    global_load_short_d16_hi v6, v143, s[32:33] nt
    global_load_short_d16_hi v7, v143, s[34:35] nt
    buffer_load_dwordx4 v134, s[4:7], s0 offen lds
    s_mov_b32 m0, s51
    s_load_dword s54, s[8:9], s1
    s_load_dword s13, s[38:39], s50
    s_setprio 3
    s_waitcnt vmcnt(7)
    v_mul_f32 v8, 0x3fb8aa3b, v8
    v_exp_f32 v8, v8
    s_setprio 2
    s_cmp_lt_u32 s2, 512
    s_cbranch_scc1 L_PB
    s_setprio 2
L_PB:
    v_cvt_pk_bf16_f32 v8, 0, v8
    s_waitcnt vmcnt(5)
    v_mul_f32 v2, v8, v2
    v_mul_f32 v36, v8, v36
    v_mul_f32 v2, 0x3fb8aa3b, v2
    v_mul_f32 v36, 0.15915494, v36
    v_mul_f32 v32, 0x41000000, v2
    v_mul_f32 v33, 0x41000000, v36
    v_exp_f32 v32, v32
    v_fract_f32 v33, v33
    v_cos_f32 v12, v33
    v_sin_f32 v13, v33
    v_mov_b32 v34, 0x3f80
    v_mul_f32 v12, v12, v32
    v_mul_f32 v13, v13, v32
    ds_write_addtid_b32 v34
    v_mov_b32 v14, v12
    v_mov_b32 v15, 1.0
    v_mul_f32 v38, v13, v13
    v_mul_f32 v32, v38, v15
    v_cvt_pk_bf16_f32 v35, v14, v15
    v_fma_f32 v15, v12, v15, v14
    v_fma_f32 v14, v12, v14, -v32
    ds_write_addtid_b32 v35 offset:288
    v_mul_f32 v32, v38, v15
    v_cvt_pk_bf16_f32 v34, v14, v15
    v_fma_f32 v15, v12, v15, v14
    v_fma_f32 v14, v12, v14, -v32
    ds_write_addtid_b32 v34 offset:576
    v_mul_f32 v32, v38, v15
    v_cvt_pk_bf16_f32 v35, v14, v15
    v_fma_f32 v15, v12, v15, v14
    v_fma_f32 v14, v12, v14, -v32
    ds_write_addtid_b32 v35 offset:864
    v_mul_f32 v32, v38, v15
    v_cvt_pk_bf16_f32 v34, v14, v15
    v_fma_f32 v15, v12, v15, v14
    v_fma_f32 v14, v12, v14, -v32
    ds_write_addtid_b32 v34 offset:1152
    v_mul_f32 v32, v38, v15
    v_cvt_pk_bf16_f32 v35, v14, v15
    v_fma_f32 v15, v12, v15, v14
    v_fma_f32 v14, v12, v14, -v32
    ds_write_addtid_b32 v35 offset:1440
    v_mul_f32 v32, v38, v15
    v_cvt_pk_bf16_f32 v34, v14, v15
    v_fma_f32 v15, v12, v15, v14
    v_fma_f32 v14, v12, v14, -v32
    ds_write_addtid_b32 v34 offset:1728
    v_mul_f32 v32, v38, v15
    v_cvt_pk_bf16_f32 v35, v14, v15
    v_fma_f32 v15, v12, v15, v14
    v_fma_f32 v14, v12, v14, -v32
    ds_write_addtid_b32 v35 offset:2016
    v_mul_f32 v32, v38, v15
    v_cvt_pk_bf16_f32 v34, v14, v15
    v_fma_f32 v15, v12, v15, v14
    v_fma_f32 v14, v12, v14, -v32
    ds_write_addtid_b32 v34 offset:2304
    v_mul_f32 v32, v38, v15
    v_cvt_pk_bf16_f32 v35, v14, v15
    v_fma_f32 v15, v12, v15, v14
    v_fma_f32 v14, v12, v14, -v32
    ds_write_addtid_b32 v35 offset:2592
    v_mul_f32 v32, v38, v15
    v_cvt_pk_bf16_f32 v34, v14, v15
    v_fma_f32 v15, v12, v15, v14
    v_fma_f32 v14, v12, v14, -v32
    ds_write_addtid_b32 v34 offset:2880
    s_waitcnt vmcnt(0) lgkmcnt(0)
    ds_read_u16_d16 v40, v39 offset:4608
    ds_read_u16_d16_hi v41, v39 offset:4736
    ds_read_u16_d16 v42, v39 offset:4864
    ds_read_u16_d16_hi v43, v39 offset:4992
    ds_read_u16_d16 v44, v39 offset:5120
    ds_read_u16_d16_hi v45, v39 offset:5248
    ds_read_u16_d16 v46, v39 offset:5376
    ds_read_u16_d16_hi v47, v39 offset:5504
    s_add_u32 s54, s54, 1
    v_mov_b32 v53, s54
    v_mov_b32 v51, s54
    s_bitcmp1_b32 s49, 0
    s_cselect_b32 s57, 0, 16
    s_lshl_b32 s13, s13, s57
    s_and_b32 s13, s13, 0xffff0000
    v_mul_f32 v32, v38, v15
    v_cvt_pk_bf16_f32 v35, v14, v15
    v_fma_f32 v15, v12, v15, v14
    v_fma_f32 v14, v12, v14, -v32
    ds_write_addtid_b32 v35 offset:3168
    v_mul_f32 v32, v38, v15
    v_cvt_pk_bf16_f32 v34, v14, v15
    v_fma_f32 v15, v12, v15, v14
    v_fma_f32 v14, v12, v14, -v32
    ds_write_addtid_b32 v34 offset:3456
    s_waitcnt lgkmcnt(2)
    v_or_b32 v48, v40, v41
    v_or_b32 v49, v42, v43
    v_or_b32 v50, v44, v45
    v_or_b32 v52, v46, v47
    s_mov_b32 exec_lo, 0x77777777
    s_mov_b32 exec_hi, 0x77777777
    v_mov_b32 v51, v52
    s_mov_b64 exec, -1
    buffer_store_dwordx4 v[48:51], v135, s[8:11], s52 offen sc1
    s_mov_b32 exec_lo, 0x88888888
    s_mov_b32 exec_hi, 0x88888888
    buffer_store_dwordx2 v[52:53], v9, s[8:11], s60 offen sc1
    s_mov_b64 exec, -1
    v_mul_f32 v32, v38, v15
    v_cvt_pk_bf16_f32 v35, v14, v15
    v_fma_f32 v15, v12, v15, v14
    v_fma_f32 v14, v12, v14, -v32
    ds_write_addtid_b32 v35 offset:3744
    v_mul_f32 v32, v38, v15
    v_cvt_pk_bf16_f32 v34, v14, v15
    v_fma_f32 v15, v12, v15, v14
    v_fma_f32 v14, v12, v14, -v32
    ds_write_addtid_b32 v34 offset:4032
    v_mul_f32 v32, v38, v15
    v_cvt_pk_bf16_f32 v35, v14, v15
    v_fma_f32 v15, v12, v15, v14
    v_fma_f32 v14, v12, v14, -v32
    ds_write_addtid_b32 v35 offset:4320
    ds_read_b128 v[72:75], v37 offset:0
    ds_read_b128 v[76:79], v37 offset:64
    ds_read_b128 v[80:83], v37 offset:128
    ds_read_b128 v[84:87], v37 offset:192
    v_mul_f32 v32, v38, v15
    v_cvt_pk_bf16_f32 v34, v14, v15
    v_fma_f32 v15, v12, v15, v14
    v_fma_f32 v14, v12, v14, -v32
    ds_write_addtid_b32 v34 offset:0
    v_mul_f32 v32, v38, v15
    v_cvt_pk_bf16_f32 v35, v14, v15
    v_fma_f32 v15, v12, v15, v14
    v_fma_f32 v14, v12, v14, -v32
    ds_write_addtid_b32 v35 offset:288
    v_mul_f32 v32, v38, v15
    v_cvt_pk_bf16_f32 v34, v14, v15
    v_fma_f32 v15, v12, v15, v14
    v_fma_f32 v14, v12, v14, -v32
    ds_write_addtid_b32 v34 offset:576
    v_mul_f32 v32, v38, v15
    v_cvt_pk_bf16_f32 v35, v14, v15
    v_fma_f32 v15, v12, v15, v14
    v_fma_f32 v14, v12, v14, -v32
    ds_write_addtid_b32 v35 offset:864
    v_mul_f32 v32, v38, v15
    v_cvt_pk_bf16_f32 v34, v14, v15
    v_fma_f32 v15, v12, v15, v14
    v_fma_f32 v14, v12, v14, -v32
    ds_write_addtid_b32 v34 offset:1152
    v_exp_f32 v32, v2
    v_fract_f32 v33, v36
    v_cos_f32 v10, v33
    v_sin_f32 v11, v33
    v_mul_f32 v4, v4, v8
    v_mul_f32 v10, v10, v32
    v_mul_f32 v11, v11, v32
    v_mul_f32 v5, v5, v8
    v_mul_f32 v32, v38, v15
    v_cvt_pk_bf16_f32 v35, v14, v15
    v_fma_f32 v15, v12, v15, v14
    v_fma_f32 v14, v12, v14, -v32
    ds_write_addtid_b32 v35 offset:1440
    v_mul_f32 v32, v38, v15
    v_cvt_pk_bf16_f32 v34, v14, v15
    v_fma_f32 v15, v12, v15, v14
    v_fma_f32 v14, v12, v14, -v32
    ds_write_addtid_b32 v34 offset:1728
    v_mul_f32 v32, v38, v15
    v_cvt_pk_bf16_f32 v35, v14, v15
    v_fma_f32 v15, v12, v15, v14
    v_fma_f32 v14, v12, v14, -v32
    ds_write_addtid_b32 v35 offset:2016
    v_mul_f32 v32, v38, v15
    v_cvt_pk_bf16_f32 v34, v14, v15
    v_fma_f32 v15, v12, v15, v14
    v_fma_f32 v14, v12, v14, -v32
    ds_write_addtid_b32 v34 offset:2304
    v_mul_f32 v32, v38, v15
    v_cvt_pk_bf16_f32 v35, v14, v15
    v_fma_f32 v15, v12, v15, v14
    v_fma_f32 v14, v12, v14, -v32
    ds_write_addtid_b32 v35 offset:2592
    v_mul_f32 v32, v38, v15
    v_cvt_pk_bf16_f32 v34, v14, v15
    v_fma_f32 v15, v12, v15, v14
    v_fma_f32 v14, v12, v14, -v32
    ds_write_addtid_b32 v34 offset:2880
    v_mul_f32 v32, v38, v15
    v_cvt_pk_bf16_f32 v35, v14, v15
    v_fma_f32 v15, v12, v15, v14
    v_fma_f32 v14, v12, v14, -v32
    ds_write_addtid_b32 v35 offset:3168
    v_mul_f32 v32, v38, v15
    v_cvt_pk_bf16_f32 v34, v14, v15
    v_fma_f32 v15, v12, v15, v14
    v_fma_f32 v14, v12, v14, -v32
    ds_write_addtid_b32 v34 offset:3456
    v_mul_f32 v32, v38, v15
    v_cvt_pk_bf16_f32 v35, v14, v15
    v_fma_f32 v15, v12, v15, v14
    v_fma_f32 v14, v12, v14, -v32
    ds_write_addtid_b32 v35 offset:3744
    v_mul_f32 v32, v38, v15
    v_cvt_pk_bf16_f32 v34, v14, v15
    v_fma_f32 v15, v12, v15, v14
    v_fma_f32 v14, v12, v14, -v32
    ds_write_addtid_b32 v34 offset:4032
    v_mul_f32 v32, v38, v15
    v_cvt_pk_bf16_f32 v35, v14, v15
    v_fma_f32 v15, v12, v15, v14
    v_fma_f32 v14, v12, v14, -v32
    ds_write_addtid_b32 v35 offset:4320
    ds_read_b128 v[88:91], v37 offset:0
    ds_read_b128 v[92:95], v37 offset:64
    ds_read_b128 v[96:99], v37 offset:128
    ds_read_b128 v[100:103], v37 offset:192
    s_setprio 2
    s_cmp_lt_u32 s2, 512
    s_cbranch_scc1 L_PQ
    s_setprio 3
L_PQ:
    v_mul_f32 v38, v38, v15
    v_mul_f32 v32, v6, v4
    v_mul_f32 v33, v6, v5
    v_fma_f32 v16, -v7, v5, v32
    v_fma_f32 v17, v7, v4, v33
    v_mul_f32 v32, v16, v10
    v_mul_f32 v33, v16, v11
    v_fma_f32 v18, -v17, v11, v32
    v_fma_f32 v19, v17, v10, v33
    v_mul_f32 v17, v13, v17
    v_cvt_pk_bf16_f32 v34, v16, -v17
    ds_write_addtid_b32 v34 offset:0
    v_mul_f32 v32, v18, v10
    v_mul_f32 v33, v18, v11
    v_fma_f32 v20, -v19, v11, v32
    v_fma_f32 v21, v19, v10, v33
    v_mul_f32 v19, v13, v19
    v_cvt_pk_bf16_f32 v35, v18, -v19
    ds_write_addtid_b32 v35 offset:288
    v_mul_f32 v32, v20, v10
    v_mul_f32 v33, v20, v11
    v_fma_f32 v22, -v21, v11, v32
    v_fma_f32 v23, v21, v10, v33
    v_mul_f32 v21, v13, v21
    v_cvt_pk_bf16_f32 v34, v20, -v21
    ds_write_addtid_b32 v34 offset:576
    v_mul_f32 v32, v22, v10
    v_mul_f32 v33, v22, v11
    v_fma_f32 v24, -v23, v11, v32
    v_fma_f32 v25, v23, v10, v33
    v_mul_f32 v23, v13, v23
    v_cvt_pk_bf16_f32 v35, v22, -v23
    ds_write_addtid_b32 v35 offset:864
    v_mul_f32 v32, v24, v10
    v_mul_f32 v33, v24, v11
    v_fma_f32 v26, -v25, v11, v32
    v_fma_f32 v27, v25, v10, v33
    v_mul_f32 v25, v13, v25
    v_cvt_pk_bf16_f32 v34, v24, -v25
    ds_write_addtid_b32 v34 offset:1152
    s_cmp_ge_u32 s2, 512
    s_cbranch_scc0 L_UL1
    s_add_u32 m0, s51, 4608
    s_nop 0
    buffer_load_dwordx4 v132, s[8:11], s15 offen sc1 lds
    buffer_load_dwordx2 v[144:145], v140, s[8:11], s14 offen sc1
    s_mov_b32 m0, s51
L_UL1:
    v_mul_f32 v32, v26, v10
    v_mul_f32 v33, v26, v11
    v_fma_f32 v28, -v27, v11, v32
    v_fma_f32 v29, v27, v10, v33
    v_mul_f32 v27, v13, v27
    v_cvt_pk_bf16_f32 v35, v26, -v27
    ds_write_addtid_b32 v35 offset:1440
    v_mul_f32 v32, v28, v10
    v_mul_f32 v33, v28, v11
    v_fma_f32 v30, -v29, v11, v32
    v_fma_f32 v31, v29, v10, v33
    v_mul_f32 v29, v13, v29
    v_cvt_pk_bf16_f32 v34, v28, -v29
    ds_write_addtid_b32 v34 offset:1728
    v_mul_f32 v31, v13, v31
    v_mul_f32 v32, v16, v14
    v_mul_f32 v33, v16, v38
    v_cvt_pk_bf16_f32 v35, v30, -v31
    v_fma_f32 v16, -v17, v15, v32
    v_fma_f32 v17, v17, v14, v33
    ds_write_addtid_b32 v35 offset:2016
    s_cmp_ge_u32 s2, 512
    s_cbranch_scc1 L_UL0
    s_add_u32 m0, s51, 4608
    s_nop 0
    buffer_load_dwordx4 v132, s[8:11], s15 offen sc1 lds
    buffer_load_dwordx2 v[144:145], v140, s[8:11], s14 offen sc1
    s_mov_b32 m0, s51
L_UL0:
    v_mul_f32 v32, v20, v14
    v_mul_f32 v33, v20, v38
    v_cvt_pk_bf16_f32 v34, v16, -v17
    v_fma_f32 v20, -v21, v15, v32
    v_fma_f32 v21, v21, v14, v33
    ds_write_addtid_b32 v34 offset:2304
    v_mul_f32 v32, v24, v14
    v_mul_f32 v33, v24, v38
    v_cvt_pk_bf16_f32 v35, v20, -v21
    v_fma_f32 v24, -v25, v15, v32
    v_fma_f32 v25, v25, v14, v33
    ds_write_addtid_b32 v35 offset:2592
    v_mul_f32 v32, v28, v14
    v_mul_f32 v33, v28, v38
    v_cvt_pk_bf16_f32 v34, v24, -v25
    v_fma_f32 v28, -v29, v15, v32
    v_fma_f32 v29, v29, v14, v33
    ds_write_addtid_b32 v34 offset:2880
    v_mul_f32 v32, v16, v14
    v_mul_f32 v33, v16, v38
    v_cvt_pk_bf16_f32 v35, v28, -v29
    v_fma_f32 v16, -v17, v15, v32
    v_fma_f32 v17, v17, v14, v33
    ds_write_addtid_b32 v35 offset:3168
    v_mul_f32 v32, v24, v14
    v_mul_f32 v33, v24, v38
    v_cvt_pk_bf16_f32 v34, v16, -v17
    v_fma_f32 v24, -v25, v15, v32
    v_fma_f32 v25, v25, v14, v33
    ds_write_addtid_b32 v34 offset:3456
    v_mul_f32 v32, v16, v14
    v_mul_f32 v33, v16, v38
    v_cvt_pk_bf16_f32 v35, v24, -v25
    v_fma_f32 v16, -v17, v15, v32
    v_fma_f32 v17, v17, v14, v33
    ds_write_addtid_b32 v35 offset:3744
    v_mul_f32 v32, v24, v14
    v_mul_f32 v33, v24, v38
    v_cvt_pk_bf16_f32 v34, v16, -v17
    v_fma_f32 v24, -v25, v15, v32
    v_fma_f32 v25, v25, v14, v33
    ds_write_addtid_b32 v34 offset:4032
    v_mul_f32 v32, v16, v14
    v_mul_f32 v33, v16, v38
    v_cvt_pk_bf16_f32 v35, v24, -v25
    v_fma_f32 v16, -v17, v15, v32
    v_fma_f32 v17, v17, v14, v33
    ds_write_addtid_b32 v35 offset:4320
    ds_read_b128 v[40:43], v37 offset:0
    ds_read_b128 v[44:47], v37 offset:64
    ds_read_b128 v[48:51], v37 offset:128
    ds_read_b128 v[52:55], v37 offset:192
    v_mul_f32 v32, v16, v14
    v_mul_f32 v33, v16, v38
    v_cvt_pk_bf16_f32 v34, v16, -v17
    v_fma_f32 v16, -v17, v15, v32
    v_fma_f32 v17, v17, v14, v33
    ds_write_addtid_b32 v34 offset:0
    v_mul_f32 v32, v16, v14
    v_mul_f32 v33, v16, v38
    v_cvt_pk_bf16_f32 v35, v16, -v17
    v_fma_f32 v16, -v17, v15, v32
    v_fma_f32 v17, v17, v14, v33
    ds_write_addtid_b32 v35 offset:288
    v_mul_f32 v32, v16, v14
    v_mul_f32 v33, v16, v38
    v_cvt_pk_bf16_f32 v34, v16, -v17
    v_fma_f32 v16, -v17, v15, v32
    v_fma_f32 v17, v17, v14, v33
    ds_write_addtid_b32 v34 offset:576
    s_waitcnt lgkmcnt(3)
    v_mfma_f32_16x16x32_bf16 v[104:107], v[40:43], v[72:75], 0
    v_mfma_f32_16x16x32_bf16 v[108:111], v[40:43], v[88:91], 0
    v_mfma_f32_16x16x32_bf16 v[104:107], v[44:47], v[76:79], v[104:107]
    v_mfma_f32_16x16x32_bf16 v[108:111], v[44:47], v[92:95], v[108:111]
    v_mul_f32 v32, v16, v14
    v_mul_f32 v33, v16, v38
    v_cvt_pk_bf16_f32 v35, v16, -v17
    v_fma_f32 v16, -v17, v15, v32
    v_fma_f32 v17, v17, v14, v33
    ds_write_addtid_b32 v35 offset:864
    v_mfma_f32_16x16x32_bf16 v[104:107], v[48:51], v[80:83], v[104:107]
    v_mfma_f32_16x16x32_bf16 v[108:111], v[48:51], v[96:99], v[108:111]
    v_mfma_f32_16x16x32_bf16 v[104:107], v[52:55], v[84:87], v[104:107]
    v_mfma_f32_16x16x32_bf16 v[108:111], v[52:55], v[100:103], v[108:111]
    v_cvt_pk_bf16_f32 v34, v16, -v17
    ds_write_addtid_b32 v34 offset:1152
    s_setprio 1
    ds_read_b128 v[56:59], v37 offset:0
    ds_read_b128 v[60:63], v37 offset:64
    ds_read_b128 v[64:67], v37 offset:128
    ds_read_b128 v[68:71], v37 offset:192
    ds_write_b128 v129, v[104:107]
    ds_write_b128 v129, v[108:111] offset:256
    s_lshl_b32 s57, s48, 10
    s_add_u32 s57, s57, 49632
    v_lshl_add_u32 v4, v1, 2, s57
    v_and_b32 v5, 15, v1
    v_mul_u32_u24 v5, 12, v5
    v_sub_u32 v5, v129, v5
    v_add_u32 v5, 2048, v5
    v_bfe_i32 v6, v0, 0, 1
    s_mov_b32 s55, 0x07060302
    s_mov_b32 s57, 0
    s_waitcnt lgkmcnt(5)
    v_mfma_f32_16x16x32_bf16 v[112:115], v[56:59], v[72:75], 0
    v_mfma_f32_16x16x32_bf16 v[116:119], v[56:59], v[88:91], 0
    s_waitcnt lgkmcnt(4)
    v_mfma_f32_16x16x32_bf16 v[112:115], v[60:63], v[76:79], v[112:115]
    v_mfma_f32_16x16x32_bf16 v[116:119], v[60:63], v[92:95], v[116:119]
    s_waitcnt lgkmcnt(3)
    v_mfma_f32_16x16x32_bf16 v[112:115], v[64:67], v[80:83], v[112:115]
    v_mfma_f32_16x16x32_bf16 v[116:119], v[64:67], v[96:99], v[116:119]
    s_waitcnt lgkmcnt(2)
    v_mfma_f32_16x16x32_bf16 v[112:115], v[68:71], v[84:87], v[112:115]
    v_mfma_f32_16x16x32_bf16 v[116:119], v[68:71], v[100:103], v[116:119]
    s_waitcnt vmcnt(0)
    ds_read_b128 v[24:27], v141 offset:4608
    v_cmp_ne_u32 s[62:63], s54, v145
    s_mov_b32 exec_hi, 0
    s_nop 3
    ds_write2_b32 v5, v112, v116 offset0:0 offset1:16
    ds_write2_b32 v5, v113, v117 offset0:32 offset1:48
    ds_write2_b32 v5, v114, v118 offset0:64 offset1:80
    ds_write2_b32 v5, v115, v119 offset0:96 offset1:112
    s_mov_b32 exec_hi, -1
    s_waitcnt lgkmcnt(4)
L_UP:
    s_mov_b32 exec_lo, 0xff000000
    s_mov_b32 exec_hi, 0xff000000
    v_cmp_ne_u32 vcc, s54, v27
    v_mov_b32 v27, v144
    s_mov_b64 exec, -1
    s_or_b64 vcc, vcc, s[62:63]
    s_cbranch_vccz L_UD
    s_add_u32 s57, s57, 1
    s_cmp_gt_u32 s57, 4000
    s_cbranch_scc1 L_UD
    s_sleep 2
    s_add_u32 m0, s51, 4608
    s_nop 0
    buffer_load_dwordx4 v132, s[8:11], s15 offen sc1 lds
    buffer_load_dwordx2 v[144:145], v140, s[8:11], s14 offen sc1
    s_mov_b32 m0, s51
    s_waitcnt vmcnt(0)
    ds_read_b128 v[24:27], v141 offset:4608
    v_cmp_ne_u32 s[62:63], s54, v145
    s_waitcnt lgkmcnt(0)
    s_branch L_UP
L_UD:
    ds_write_b128 v127, v[24:27] offset:13536
    ds_read2st64_b32 v[28:29], v4 offset0:0 offset1:1
    ds_read2st64_b32 v[30:31], v4 offset0:2 offset1:3
    s_lshl_b32 s57, s48, 10
    s_add_u32 m0, s57, 36096
    s_waitcnt lgkmcnt(3)
    s_barrier
    ds_read2st64_b32 v[80:81], v130 offset0:0 offset1:12
    ds_read2st64_b32 v[82:83], v130 offset0:24 offset1:36
    s_cmp_eq_u32 s48, 3
    s_cbranch_scc1 L_G3
    s_cmp_eq_u32 s48, 2
    s_cbranch_scc1 L_G2
    ds_read2st64_b32 v[40:41], v128 offset0:0 offset1:12
    ds_read2st64_b32 v[42:43], v128 offset0:24 offset1:36
    s_waitcnt lgkmcnt(0)
    v_add_f32 v80, v80, v81
    v_add_f32 v82, v82, v83
    v_add_f32 v80, v80, v82
    v_add_f32 v40, v40, v41
    v_add_f32 v42, v42, v43
    v_add_f32 v40, v40, v42
    v_bitop3_b32 v41, v6, v40, v80 bitop3:0xca
    v_cvt_pk_bf16_f32 v76, v80, v80
    v_cvt_pk_bf16_f32 v72, v80, v80
    v_cvt_pk_bf16_f32 v77, v80, v41
    v_cvt_pk_bf16_f32 v73, v41, v40
    v_cvt_pk_bf16_f32 v78, v40, v40
    v_cvt_pk_bf16_f32 v74, v40, v40
    v_cvt_pk_bf16_f32 v79, v40, v40
    v_cvt_pk_bf16_f32 v75, v40, v40
    s_branch L_GE
L_G2:
    ds_read2st64_b64 v[40:43], v128 offset0:0 offset1:6
    ds_read2st64_b64 v[44:47], v128 offset0:12 offset1:18
    s_mov_b64 exec, 0x7f
    ds_write_b128 v3, v[136:139] offset:31392
    ds_write_b128 v3, v[136:139] offset:35600
    s_mov_b64 exec, -1
    s_waitcnt lgkmcnt(2)
    v_add_f32 v80, v80, v81
    v_add_f32 v82, v82, v83
    v_add_f32 v80, v80, v82
    v_add_f32 v40, v40, v42
    v_add_f32 v44, v44, v46
    v_add_f32 v41, v41, v43
    v_add_f32 v45, v45, v47
    v_add_f32 v40, v40, v44
    v_add_f32 v41, v41, v45
    v_cvt_pk_bf16_f32 v76, v80, v80
    v_cvt_pk_bf16_f32 v72, v80, v41
    v_cvt_pk_bf16_f32 v77, v41, v41
    v_cvt_pk_bf16_f32 v73, v41, v41
    v_cvt_pk_bf16_f32 v78, v41, v40
    v_cvt_pk_bf16_f32 v74, v40, v40
    v_cvt_pk_bf16_f32 v79, v40, v40
    v_cvt_pk_bf16_f32 v75, v40, v40
    s_branch L_GE
L_G3:
    v_add_u32 v6, 508, v142
    v_and_b32 v6, 511, v6
    ds_read_b128 v[40:43], v128 offset:0
    ds_read_b128 v[44:47], v128 offset:3072
    ds_read_b128 v[48:51], v128 offset:6144
    ds_read_b128 v[52:55], v128 offset:9216
    ds_read_b128 v[56:59], v142 offset:512
    ds_read_b128 v[60:63], v142 offset:3584
    ds_read_b128 v[64:67], v142 offset:6656
    ds_read_b128 v[68:71], v142 offset:9728
    ds_read2st64_b32 v[84:85], v6 offset0:2 offset1:14
    ds_read2st64_b32 v[86:87], v6 offset0:26 offset1:38
    s_waitcnt lgkmcnt(6)
    v_add_f32 v80, v80, v81
    v_add_f32 v82, v82, v83
    v_add_f32 v80, v80, v82
    v_add_f32 v40, v40, v44
    v_add_f32 v48, v48, v52
    v_add_f32 v41, v41, v45
    v_add_f32 v49, v49, v53
    v_add_f32 v42, v42, v46
    v_add_f32 v50, v50, v54
    v_add_f32 v43, v43, v47
    v_add_f32 v51, v51, v55
    v_add_f32 v40, v40, v48
    v_add_f32 v41, v41, v49
    v_add_f32 v42, v42, v50
    v_add_f32 v43, v43, v51
    s_waitcnt lgkmcnt(0)
    v_add_f32 v56, v56, v60
    v_add_f32 v64, v64, v68
    v_add_f32 v57, v57, v61
    v_add_f32 v65, v65, v69
    v_add_f32 v58, v58, v62
    v_add_f32 v66, v66, v70
    v_add_f32 v59, v59, v63
    v_add_f32 v67, v67, v71
    v_add_f32 v56, v56, v64
    v_add_f32 v57, v57, v65
    v_add_f32 v58, v58, v66
    v_add_f32 v59, v59, v67
    v_add_f32 v84, v84, v85
    v_add_f32 v86, v86, v87
    v_add_f32 v84, v84, v86
    s_mov_b32 exec_lo, 0
    s_mov_b32 exec_hi, 0x80000000
    v_add_f32 v40, s13, v40
    v_mov_b32 v84, 0
    s_mov_b64 exec, 0x7fffffff
    v_mov_b32 v84, v40
    s_mov_b32 exec_lo, -1
    v_cvt_pk_bf16_f32 v76, v80, v43
    v_cvt_pk_bf16_f32 v72, v43, v42
    v_cvt_pk_bf16_f32 v77, v42, v42
    v_cvt_pk_bf16_f32 v73, v42, v42
    v_cvt_pk_bf16_f32 v78, v42, v41
    v_cvt_pk_bf16_f32 v74, v41, v40
    v_cvt_pk_bf16_f32 v79, v40, v40
    v_cvt_pk_bf16_f32 v75, v40, v84
    s_not_b64 exec, exec
    v_cvt_pk_bf16_f32 v76, v59, v58
    v_cvt_pk_bf16_f32 v72, v58, v57
    v_cvt_pk_bf16_f32 v77, v57, v56
    v_cvt_pk_bf16_f32 v73, v56, v43
    v_cvt_pk_bf16_f32 v78, v43, v42
    v_cvt_pk_bf16_f32 v74, v42, v41
    v_cvt_pk_bf16_f32 v79, v41, v40
    v_cvt_pk_bf16_f32 v75, v40, v84
    s_mov_b64 exec, -1
L_GE:
    ds_write_addtid_b32 v28 offset:12
    ds_write_addtid_b32 v29 offset:268
    ds_write_addtid_b32 v30 offset:524
    ds_write_addtid_b32 v31 offset:780
    ds_write_addtid_b32 v28 offset:4520
    ds_write_addtid_b32 v29 offset:4776
    ds_write_addtid_b32 v30 offset:5032
    ds_write_addtid_b32 v31 offset:5288
    ds_write_addtid_b32 v28 offset:9028
    ds_write_addtid_b32 v29 offset:9284
    ds_write_addtid_b32 v30 offset:9540
    ds_write_addtid_b32 v31 offset:9796
    ds_write_b128 v131, v[76:79] offset:31504
    ds_write_b128 v131, v[72:75] offset:27296
    s_add_u32 s54, s54, 1
    v_mov_b32 v135, s54
    v_mov_b32 v132, v9
    s_lshl_b32 s60, s49, 9
    s_lshl_b32 s57, s48, 7
    s_add_u32 s60, s60, s57
    s_add_u32 s60, s60, 4390912
    s_waitcnt lgkmcnt(0)
    s_barrier
    s_setprio 1
    ds_read_b128 v[4:7], v121 offset:64
    ds_read_b128 v[8:11], v120 offset:3648
    ds_read_b128 v[12:15], v121 offset:576
    ds_read_b128 v[16:19], v120 offset:3136
    ds_read_b128 v[20:23], v121 offset:1088
    ds_read_b128 v[24:27], v120 offset:2624
    ds_read_b128 v[28:31], v121 offset:1600
    ds_read_b128 v[32:35], v120 offset:2112
    s_waitcnt lgkmcnt(6)
    v_mfma_f32_16x16x32_bf16 v[136:139], v[8:11], v[4:7], 0
    ds_read_b128 v[36:39], v121 offset:2112
    s_waitcnt lgkmcnt(6)
    v_mfma_f32_16x16x32_bf16 v[140:143], v[8:11], v[12:15], 0
    ds_read_b128 v[40:43], v120 offset:1600
    s_waitcnt lgkmcnt(6)
    v_mfma_f32_16x16x32_bf16 v[140:143], v[16:19], v[4:7], v[140:143]
    ds_read_b128 v[44:47], v121 offset:2624
    v_mfma_f32_16x16x32_bf16 v[144:147], v[16:19], v[12:15], 0
    ds_read_b128 v[48:51], v120 offset:1088
    s_waitcnt lgkmcnt(7)
    v_mfma_f32_16x16x32_bf16 v[144:147], v[8:11], v[20:23], v[144:147]
    ds_read_b128 v[52:55], v121 offset:3136
    v_mfma_f32_16x16x32_bf16 v[148:151], v[16:19], v[20:23], 0
    ds_read_b128 v[56:59], v120 offset:576
    s_waitcnt lgkmcnt(8)
    v_mfma_f32_16x16x32_bf16 v[144:147], v[24:27], v[4:7], v[144:147]
    ds_read_b128 v[60:63], v121 offset:3648
    v_mfma_f32_16x16x32_bf16 v[148:151], v[24:27], v[12:15], v[148:151]
    ds_read_b128 v[64:67], v120 offset:64
    v_mfma_f32_16x16x32_bf16 v[152:155], v[24:27], v[20:23], 0
    ds_read_b128 v[68:71], v121 offset:0
    s_waitcnt lgkmcnt(10)
    v_mfma_f32_16x16x32_bf16 v[148:151], v[8:11], v[28:31], v[148:151]
    ds_read_b128 v[72:75], v120 offset:3584
    v_mfma_f32_16x16x32_bf16 v[152:155], v[16:19], v[28:31], v[152:155]
    ds_read_b128 v[76:79], v121 offset:512
    v_mfma_f32_16x16x32_bf16 v[156:159], v[24:27], v[28:31], 0
    ds_read_b128 v[80:83], v120 offset:3072
    s_waitcnt lgkmcnt(12)
    v_mfma_f32_16x16x32_bf16 v[148:151], v[32:35], v[4:7], v[148:151]
    ds_read_b128 v[84:87], v121 offset:1024
    v_mfma_f32_16x16x32_bf16 v[152:155], v[32:35], v[12:15], v[152:155]
    ds_read_b128 v[88:91], v120 offset:2560
    v_mfma_f32_16x16x32_bf16 v[156:159], v[32:35], v[20:23], v[156:159]
    ds_read_b128 v[92:95], v121 offset:1536
    v_mfma_f32_16x16x32_bf16 v[160:163], v[32:35], v[28:31], 0
    s_waitcnt lgkmcnt(14)
    v_mfma_f32_16x16x32_bf16 v[152:155], v[8:11], v[36:39], v[152:155]
    ds_read_b128 v[96:99], v120 offset:2048
    v_mfma_f32_16x16x32_bf16 v[156:159], v[16:19], v[36:39], v[156:159]
    v_mfma_f32_16x16x32_bf16 v[160:163], v[24:27], v[36:39], v[160:163]
    v_mfma_f32_16x16x32_bf16 v[164:167], v[32:35], v[36:39], 0
    s_waitcnt lgkmcnt(14)
    v_mfma_f32_16x16x32_bf16 v[152:155], v[40:43], v[4:7], v[152:155]
    ds_read_b128 v[100:103], v121 offset:2048
    v_mfma_f32_16x16x32_bf16 v[156:159], v[40:43], v[12:15], v[156:159]
    v_mfma_f32_16x16x32_bf16 v[160:163], v[40:43], v[20:23], v[160:163]
    v_mfma_f32_16x16x32_bf16 v[164:167], v[40:43], v[28:31], v[164:167]
    s_waitcnt lgkmcnt(14)
    v_mfma_f32_16x16x32_bf16 v[156:159], v[8:11], v[44:47], v[156:159]
    ds_read_b128 v[104:107], v120 offset:1536
    v_mfma_f32_16x16x32_bf16 v[160:163], v[16:19], v[44:47], v[160:163]
    v_mfma_f32_16x16x32_bf16 v[164:167], v[24:27], v[44:47], v[164:167]
    s_waitcnt lgkmcnt(14)
    v_mfma_f32_16x16x32_bf16 v[156:159], v[48:51], v[4:7], v[156:159]
    ds_read_b128 v[108:111], v121 offset:2560
    v_mfma_f32_16x16x32_bf16 v[160:163], v[48:51], v[12:15], v[160:163]
    v_mfma_f32_16x16x32_bf16 v[164:167], v[48:51], v[20:23], v[164:167]
    s_waitcnt lgkmcnt(14)
    v_mfma_f32_16x16x32_bf16 v[160:163], v[8:11], v[52:55], v[160:163]
    ds_read_b128 v[112:115], v120 offset:1024
    v_mfma_f32_16x16x32_bf16 v[164:167], v[16:19], v[52:55], v[164:167]
    s_waitcnt lgkmcnt(14)
    v_mfma_f32_16x16x32_bf16 v[160:163], v[56:59], v[4:7], v[160:163]
    ds_read_b128 v[32:35], v121 offset:3072
    v_mfma_f32_16x16x32_bf16 v[164:167], v[56:59], v[12:15], v[164:167]
    s_waitcnt lgkmcnt(14)
    v_mfma_f32_16x16x32_bf16 v[164:167], v[8:11], v[60:63], v[164:167]
    ds_read_b128 v[36:39], v120 offset:512
    s_waitcnt lgkmcnt(14)
    v_mfma_f32_16x16x32_bf16 v[164:167], v[64:67], v[4:7], v[164:167]
    ds_read_b128 v[40:43], v121 offset:3584
    s_waitcnt lgkmcnt(13)
    v_mfma_f32_16x16x32_bf16 v[136:139], v[72:75], v[68:71], v[136:139]
    ds_read_b128 v[28:31], v120 offset:0
    s_waitcnt lgkmcnt(13)
    v_mfma_f32_16x16x32_bf16 v[140:143], v[72:75], v[76:79], v[140:143]
    s_waitcnt lgkmcnt(12)
    v_mfma_f32_16x16x32_bf16 v[140:143], v[80:83], v[68:71], v[140:143]
    v_mfma_f32_16x16x32_bf16 v[144:147], v[80:83], v[76:79], v[144:147]
    s_waitcnt lgkmcnt(11)
    v_mfma_f32_16x16x32_bf16 v[144:147], v[72:75], v[84:87], v[144:147]
    v_mfma_f32_16x16x32_bf16 v[148:151], v[80:83], v[84:87], v[148:151]
    s_waitcnt lgkmcnt(10)
    v_mfma_f32_16x16x32_bf16 v[144:147], v[88:91], v[68:71], v[144:147]
    v_mfma_f32_16x16x32_bf16 v[148:151], v[88:91], v[76:79], v[148:151]
    ds_write2st64_b32 v126, v137, v138 offset0:0 offset1:8
    v_mfma_f32_16x16x32_bf16 v[152:155], v[88:91], v[84:87], v[152:155]
    s_waitcnt lgkmcnt(10)
    v_mfma_f32_16x16x32_bf16 v[148:151], v[72:75], v[92:95], v[148:151]
    ds_write2st64_b32 v126, v141, v142 offset0:1 offset1:9
    v_mfma_f32_16x16x32_bf16 v[152:155], v[80:83], v[92:95], v[152:155]
    ds_write2st64_b32 v126, v139, v143 offset0:16 offset1:17
    v_mfma_f32_16x16x32_bf16 v[156:159], v[88:91], v[92:95], v[156:159]
    s_waitcnt lgkmcnt(11)
    v_mfma_f32_16x16x32_bf16 v[148:151], v[96:99], v[68:71], v[148:151]
    v_mfma_f32_16x16x32_bf16 v[152:155], v[96:99], v[76:79], v[152:155]
    ds_write2st64_b32 v126, v145, v146 offset0:2 offset1:10
    v_mfma_f32_16x16x32_bf16 v[156:159], v[96:99], v[84:87], v[156:159]
    v_mfma_f32_16x16x32_bf16 v[160:163], v[96:99], v[92:95], v[160:163]
    s_waitcnt lgkmcnt(11)
    v_mfma_f32_16x16x32_bf16 v[152:155], v[72:75], v[100:103], v[152:155]
    v_mfma_f32_16x16x32_bf16 v[156:159], v[80:83], v[100:103], v[156:159]
    v_mfma_f32_16x16x32_bf16 v[160:163], v[88:91], v[100:103], v[160:163]
    v_mfma_f32_16x16x32_bf16 v[164:167], v[96:99], v[100:103], v[164:167]
    ds_write2st64_b32 v126, v149, v150 offset0:3 offset1:11
    s_waitcnt lgkmcnt(11)
    v_mfma_f32_16x16x32_bf16 v[152:155], v[104:107], v[68:71], v[152:155]
    ds_write2st64_b32 v126, v147, v151 offset0:18 offset1:19
    v_mfma_f32_16x16x32_bf16 v[156:159], v[104:107], v[76:79], v[156:159]
    v_mfma_f32_16x16x32_bf16 v[160:163], v[104:107], v[84:87], v[160:163]
    v_mfma_f32_16x16x32_bf16 v[164:167], v[104:107], v[92:95], v[164:167]
    s_waitcnt lgkmcnt(11)
    v_mfma_f32_16x16x32_bf16 v[156:159], v[72:75], v[108:111], v[156:159]
    v_mfma_f32_16x16x32_bf16 v[160:163], v[80:83], v[108:111], v[160:163]
    v_mfma_f32_16x16x32_bf16 v[164:167], v[88:91], v[108:111], v[164:167]
    s_waitcnt lgkmcnt(10)
    v_mfma_f32_16x16x32_bf16 v[156:159], v[112:115], v[68:71], v[156:159]
    ds_write2st64_b32 v126, v153, v154 offset0:4 offset1:12
    v_mfma_f32_16x16x32_bf16 v[160:163], v[112:115], v[76:79], v[160:163]
    v_mfma_f32_16x16x32_bf16 v[164:167], v[112:115], v[84:87], v[164:167]
    s_waitcnt lgkmcnt(10)
    v_mfma_f32_16x16x32_bf16 v[160:163], v[72:75], v[32:35], v[160:163]
    v_mfma_f32_16x16x32_bf16 v[164:167], v[80:83], v[32:35], v[164:167]
    s_waitcnt lgkmcnt(9)
    v_mfma_f32_16x16x32_bf16 v[160:163], v[36:39], v[68:71], v[160:163]
    v_mfma_f32_16x16x32_bf16 v[164:167], v[36:39], v[76:79], v[164:167]
    s_waitcnt lgkmcnt(8)
    v_mfma_f32_16x16x32_bf16 v[164:167], v[72:75], v[40:43], v[164:167]
    ds_write2st64_b32 v126, v157, v158 offset0:5 offset1:13
    s_waitcnt lgkmcnt(8)
    v_mfma_f32_16x16x32_bf16 v[164:167], v[28:31], v[68:71], v[164:167]
    ds_write2st64_b32 v126, v155, v159 offset0:20 offset1:21
    s_setprio 3
    ds_write2st64_b32 v126, v161, v162 offset0:6 offset1:14
    s_nop 4
    ds_write2st64_b32 v126, v165, v166 offset0:7 offset1:15
    ds_write2st64_b32 v126, v163, v167 offset0:22 offset1:23
    s_waitcnt lgkmcnt(0)
    s_barrier
    ds_read2st64_b32 v[4:5], v123 offset0:0 offset1:1
    ds_read2st64_b32 v[6:7], v124 offset0:8 offset1:9
    ds_read2st64_b32 v[8:9], v125 offset0:16 offset1:17
    ds_read2st64_b32 v[10:11], v123 offset0:2 offset1:3
    ds_read2st64_b32 v[12:13], v124 offset0:10 offset1:11
    ds_read2st64_b32 v[14:15], v125 offset0:18 offset1:19
    ds_read2st64_b32 v[16:17], v123 offset0:4 offset1:5
    ds_read2st64_b32 v[18:19], v124 offset0:12 offset1:13
    ds_read2st64_b32 v[20:21], v125 offset0:20 offset1:21
    ds_read2st64_b32 v[22:23], v123 offset0:6 offset1:7
    ds_read2st64_b32 v[24:25], v124 offset0:14 offset1:15
    ds_read2st64_b32 v[26:27], v125 offset0:22 offset1:23
    s_waitcnt lgkmcnt(9)
    v_add_f32 v4, v4, v6
    v_add_f32 v5, v5, v7
    v_add_f32 v8, v8, v136
    v_add_f32 v9, v9, v140
    v_add_f32 v4, v4, v8
    v_add_f32 v5, v5, v9
    v_cvt_pk_bf16_f32 v28, v4, v5
    s_waitcnt lgkmcnt(6)
    v_add_f32 v10, v10, v12
    v_add_f32 v11, v11, v13
    v_add_f32 v14, v14, v144
    v_add_f32 v15, v15, v148
    v_add_f32 v10, v10, v14
    v_add_f32 v11, v11, v15
    v_cvt_pk_bf16_f32 v29, v10, v11
    s_waitcnt lgkmcnt(3)
    v_add_f32 v16, v16, v18
    v_add_f32 v17, v17, v19
    v_add_f32 v20, v20, v152
    v_add_f32 v21, v21, v156
    v_add_f32 v16, v16, v20
    v_add_f32 v17, v17, v21
    v_cvt_pk_bf16_f32 v30, v16, v17
    s_waitcnt lgkmcnt(0)
    v_add_f32 v22, v22, v24
    v_add_f32 v23, v23, v25
    v_add_f32 v26, v26, v160
    v_add_f32 v27, v27, v164
    v_add_f32 v22, v22, v26
    v_add_f32 v23, v23, v27
    v_cvt_pk_bf16_f32 v31, v22, v23
    s_mov_b32 exec_lo, 0x88888888
    s_mov_b32 exec_hi, 0x88888888
    v_mov_b32 v134, v31
    v_mov_b32 v31, v135
    s_mov_b64 exec, -1
    buffer_store_dwordx4 v[28:31], v122, s[8:11], s56 offen sc1
    s_mov_b32 exec_lo, 0x88888888
    s_mov_b32 exec_hi, 0x88888888
    buffer_store_dwordx2 v[134:135], v132, s[8:11], s60 offen sc1
    s_endpgm
L_EXIT:
    s_endpgm
L_CODE_END:
.section .rodata,"a"
.p2align 6
.amdhsa_kernel gated_mix__spectral_gfnet__ssm_conv_s4__prompt_kernel
  .amdhsa_next_free_vgpr 168
  .amdhsa_next_free_sgpr 64
  .amdhsa_accum_offset 168
  .amdhsa_group_segment_fixed_size 0
  .amdhsa_kernarg_size 128
  .amdhsa_user_sgpr_count 2
  .amdhsa_user_sgpr_kernarg_segment_ptr 1
  .amdhsa_system_sgpr_workgroup_id_x 1
.end_amdhsa_kernel
```
